```python
import torch

def _softmax(x, axis=-1):
    return torch.softmax(x, dim=axis)

def _gelu(x):
    return torch.nn.functional.gelu(x, approximate='tanh')

def _silu(x):
    return torch.nn.functional.silu(x)

def _sigmoid(x):
    return torch.sigmoid(x)

def _layernorm(x, axis=-1, eps=1e-05):
    m = x.mean(dim=axis, keepdim=True)
    v = x.var(dim=axis, keepdim=True, unbiased=False)
    return (x - m) / torch.sqrt(v + eps)

def _scatter_add(tgt, idx, src, axis=0):
    return tgt.clone().index_add_(axis, idx, src)

def _segment_sum(src, seg, n):
    out = torch.zeros((n,) + src.shape[1:], dtype=src.dtype)
    return out.index_add_(0, seg, src)

def _pad(x, pw):
    flat = tuple((v for pair in reversed(pw) for v in pair))
    return torch.nn.functional.pad(x, flat)
kernel_name = 'adaLN_cond__ssm_conv_s4d__dense_activation_relu__prompt'

def setup_inputs():

    _w = lambda a: (lambda t: t.to(torch.bfloat16) if t.is_floating_point() else t)(torch.as_tensor(a))

    def _A_setup():
        Bsz, L, D, N = (1, 2048, 576, 128)
        return {'u': _w((lambda *s: torch.randn(*s, dtype=torch.bfloat16) * 0.05)(Bsz, L, D)), 'log_A_real': _w((lambda *s: torch.randn(*s, dtype=torch.bfloat16) * 3.2)(D, N) * 0.5), 'A_imag': _w((lambda *s: torch.randn(*s, dtype=torch.bfloat16) * 0.1)(D, N) * 3.14), 'C_real': _w((lambda *s: torch.randn(*s, dtype=torch.bfloat16) * 0.8)(D, N) / N ** 0.5), 'C_imag': _w((lambda *s: torch.randn(*s, dtype=torch.bfloat16) * 0.8)(D, N) / N ** 0.5), 'log_dt': _w((lambda *s: torch.randn(*s, dtype=torch.bfloat16) * 0.1)(D) * 0.5 - 4.0), 'D_skip': _w((lambda *s: torch.randn(*s, dtype=torch.bfloat16) * 0.1)(D))}
    _A_in = _A_setup()

    def _B_setup():
        B, S, D, Dff = (1, 2048, 576, 4608)
        return {'x': _w((lambda *s: torch.randn(*s, dtype=torch.bfloat16) * 0.05)(B, S, D)), 'w1': _w((lambda *s: torch.randn(*s, dtype=torch.bfloat16) * 0.05)(D, Dff)), 'w2': _w((lambda *s: torch.randn(*s, dtype=torch.bfloat16) * 0.05)(Dff, D))}
    _B_in = _B_setup()
    return {'A_u': _A_in['u'], 'A_log_A_real': _A_in['log_A_real'], 'A_A_imag': _A_in['A_imag'], 'A_C_real': _A_in['C_real'], 'A_C_imag': _A_in['C_imag'], 'A_log_dt': _A_in['log_dt'], 'A_D_skip': _A_in['D_skip'], 'B_x': _B_in['x'], 'B_w1': _B_in['w1'], 'B_w2': _B_in['w2'], 'c': _w((lambda *s: torch.randn(*s, dtype=torch.bfloat16) * 0.2)(1, 576) * 8.0), 'w_mod': _w((lambda *s: torch.randn(*s, dtype=torch.bfloat16) * 0.2)(576, 6 * 576) * 576 ** (-0.5) * 8.0)}

def reference(A_u, A_log_A_real, A_A_imag, A_C_real, A_C_imag, A_log_dt, A_D_skip, B_x, B_w1, B_w2, c, w_mod):

    def _A_ref(u, log_A_real, A_imag, C_real, C_imag, log_dt, D_skip):
        L = u.shape[1]
        dt = torch.exp(log_dt)
        A = -torch.exp(log_A_real) + 1j * A_imag
        C = (C_real + 1j * C_imag) * dt[:, None]
        pos = (lambda x, dt: x.to(dt))(torch.arange(L), log_dt.dtype)
        P = torch.exp((A * dt[:, None])[:, :, None] * pos[None, None, :])
        K = 2.0 * torch.einsum('dn,dnl->dl', C, P).real
        L2 = 2 * L
        u_t = (lambda x, *d: x.permute(*d))(u, 0, 2, 1)
        Kf = (lambda x, *a, **k: torch.fft.rfft(x.float(), *a, **k))(K, L2)
        Uf = (lambda x, *a, **k: torch.fft.rfft(x.float(), *a, **k))(u_t, L2)
        y = (lambda x, *a, **k: torch.fft.irfft(x, *a, **k).to(torch.bfloat16))(Uf * Kf[None, :, :], L2)[:, :, :L]
        y = (lambda x, *d: x.permute(*d))(y, 0, 2, 1)
        return y + u * D_skip[None, None, :]

    def _B_ref(x, w1, w2):
        h = torch.einsum('bsd,df->bsf', x, w1)
        zero = torch.zeros_like(h)
        h = torch.maximum(h, zero)
        return torch.einsum('bsf,fd->bsd', h, w2)
    x = A_u
    mod = (_silu(c) @ w_mod).reshape(c.shape[0], 6, 1, -1)
    sa, ca, ga, sb, cb, gb = (mod[:, 0].clone(), mod[:, 1].clone(), mod[:, 2].clone(), mod[:, 3].clone(), mod[:, 4].clone(), mod[:, 5].clone())
    h = _layernorm(x, axis=-1) * (1 + ca) + sa
    x = x + ga * _A_ref(h, A_log_A_real, A_A_imag, A_C_real, A_C_imag, A_log_dt, A_D_skip)
    h = _layernorm(x, axis=-1) * (1 + cb) + sb
    x = x + gb * _B_ref(h, B_w1, B_w2)
    return x
```

```asm
; @launch kernel=front_kernel grid=(256,1,1) block=(256,1,1) lds=147840
; @launch kernel=ffn_kernel grid=(256,1,1) block=(256,1,1) lds=148480
.amdgcn_target "amdgcn-amd-amdhsa--gfx950"
.text
.globl front_kernel
.p2align 8
.type front_kernel,@function
front_kernel:
    s_cmp_ge_u32 s2, 256
    s_cbranch_scc1 F_exit
    s_load_dwordx2 s[4:5], s[0:1], 0
    s_load_dwordx4 s[8:11], s[0:1], 8
    s_load_dwordx8 s[20:27], s[0:1], 24
    s_load_dwordx8 s[44:51], s[0:1], 64
    s_load_dwordx4 s[36:39], s[0:1], 104
    s_mul_i32 s17, s2, 9216
    v_lshrrev_b32 v1, 5, v0
    v_and_b32 v2, 31, v0
    v_mul_u32_u24 v3, 1152, v1
    v_lshl_add_u32 v3, v2, 2, v3
    v_add_u32 v3, s17, v3
    v_mul_u32_u24 v1, 1184, v1
    v_lshl_add_u32 v1, v2, 2, v1
    v_add_u32 v1, 128384, v1
    v_lshrrev_b32 v60, 6, v0
    s_sub_u32 s3, s2, 144
    s_lshr_b32 s43, s3, 3
    s_and_b32 s30, s3, 7
    s_lshr_b32 s18, s43, 1
    s_lshl_b32 s18, s18, 3
    s_add_u32 s30, s30, s18
    s_lshl_b32 s30, s30, 1
    s_and_b32 s19, s43, 1
    s_add_u32 s3, s30, s19
    v_and_b32 v65, 3, v0
    v_and_b32 v78, 63, v0
    s_waitcnt lgkmcnt(0)
    global_load_dword v4, v3, s[4:5] offset:0
    global_load_dword v5, v3, s[4:5] offset:128
    global_load_dword v6, v3, s[4:5] offset:256
    global_load_dword v7, v3, s[4:5] offset:384
    global_load_dword v8, v3, s[4:5] offset:512
    global_load_dword v9, v3, s[4:5] offset:640
    global_load_dword v10, v3, s[4:5] offset:768
    global_load_dword v11, v3, s[4:5] offset:896
    global_load_dword v12, v3, s[4:5] offset:1024
    s_mov_b32 s41, 7217152
    s_load_dword s40, s[38:39], s41
    s_mov_b32 s12, s38
    s_mov_b32 s13, s39
    s_mov_b32 s14, 0x10000000
    s_mov_b32 s15, 0x20000
    v_readfirstlane_b32 s16, v60
    s_cmp_ge_u32 s2, 144
    s_cbranch_scc1 F_hp
    s_lshl_b32 s30, s2, 2
    s_add_u32 s30, s30, s16
    s_lshl_b32 s19, s30, 8
    v_lshl_add_u32 v64, v78, 2, s19
    s_lshl_b32 s19, s30, 1
    v_mov_b32 v66, s19
    global_load_ushort v68, v66, s[24:25]
    global_load_dword v70, v64, s[8:9]
    global_load_dword v72, v64, s[10:11]
    global_load_dword v74, v64, s[20:21]
    global_load_dword v76, v64, s[22:23]
    global_load_ushort v69, v66, s[26:27]
    s_getpc_b64 s[28:29]
F_pc:
    v_lshlrev_b32 v64, 7, v0
    v_min_u32 v64, C_exit-F_pc, v64
    s_cmp_lt_u32 s2, 8
    s_cselect_b64 exec, -1, 1
    global_load_dword v64, v64, s[28:29]
    s_mov_b64 exec, -1
    s_mul_i32 s23, s16, 32096
    s_movk_i32 s31, 544
    v_and_b32 v232, 7, v78
    v_sub_u32 v232, 7, v232
    v_lshlrev_b32 v232, 2, v232
    v_and_b32 v47, 8, v78
    v_cmp_eq_u32 vcc, 0, v47
    v_lshrrev_b32 v61, 4, v78
    v_lshl_add_u32 v61, v61, 4, s23
    v_and_b32 v230, 15, v78
    v_mad_u32_u24 v233, v230, s31, v61
    s_mov_b32 s58, 0x76543210
    s_mov_b32 s59, 0x43222100
    v_bfe_u32 v47, s58, v232, 4
    v_bfe_u32 v231, s59, v232, 4
    v_add_u32 v47, 0, v47
    v_add_u32 v231, 8, v231
    v_cndmask_b32 v47, v231, v47, vcc
    v_mad_u32_u24 v234, v47, s31, v61
    s_mov_b32 s58, 0x22111000
    s_mov_b32 s59, 0x22111000
    v_bfe_u32 v47, s58, v232, 4
    v_bfe_u32 v231, s59, v232, 4
    v_add_u32 v47, 13, v47
    v_add_u32 v231, 16, v231
    v_cndmask_b32 v47, v231, v47, vcc
    v_mad_u32_u24 v235, v47, s31, v61
    s_mov_b32 s58, 0x11100000
    s_mov_b32 s59, 0x11100000
    v_bfe_u32 v47, s58, v232, 4
    v_bfe_u32 v231, s59, v232, 4
    v_add_u32 v47, 19, v47
    v_add_u32 v231, 21, v231
    v_cndmask_b32 v47, v231, v47, vcc
    v_mad_u32_u24 v236, v47, s31, v61
    s_mov_b32 s58, 0x11100000
    s_mov_b32 s59, 0x11100000
    v_bfe_u32 v47, s58, v232, 4
    v_bfe_u32 v231, s59, v232, 4
    v_add_u32 v47, 23, v47
    v_add_u32 v231, 25, v231
    v_cndmask_b32 v47, v231, v47, vcc
    v_mad_u32_u24 v237, v47, s31, v61
    v_bfe_u32 v231, v78, 4, 1
    v_lshrrev_b32 v232, 5, v78
    v_lshlrev_b32 v230, 4, v230
    v_lshl_add_u32 v230, v232, 9, v230
    v_lshlrev_b32 v231, 3, v231
    v_sub_u32 v230, v231, v230
    s_add_u32 s19, s23, 752
    v_add_u32 v230, s19, v230
    v_and_b32 v231, 0x11, v78
    v_cmp_eq_u32 s[58:59], 16, v78
    v_cmp_eq_u32 s[60:61], 1, v231
    v_lshrrev_b32 v231, 5, v78
    v_mul_u32_u24 v231, 4160, v231
    v_add_u32 v231, s23, v231
    v_and_b32 v232, 15, v78
    v_lshl_add_u32 v232, v232, 2, v231
    v_lshrrev_b32 v47, 2, v78
    s_add_u32 s27, s23, 8320
    v_min_u32 v246, 29, v78
    v_lshl_add_u32 v246, v246, 4, s27
    v_mul_u32_u24 v245, 32096, v65
    v_lshl_add_u32 v245, v47, 4, v245
    s_lshl_b32 s28, s16, 10
    s_add_u32 s28, s28, 8800
    v_add_u32 v245, s28, v245
    v_and_b32 v56, 15, v78
    v_lshrrev_b32 v57, 4, v78
    v_sub_u32 v58, 1, v56
    v_and_b32 v58, 1, v58
    v_mul_u32_u24 v241, 4158, v58
    v_lshlrev_b32 v59, 1, v56
    v_sub_u32 v241, v241, v59
    v_lshl_add_u32 v241, v57, 4, v241
    s_add_u32 s28, s23, 478
    v_add_u32 v60, s28, v241
    v_add_u32 v239, 1024, v60
    v_add_u32 v240, 2048, v60
    v_add_u32 v241, 3072, v60
    v_mov_b32 v238, v60
    v_lshlrev_b32 v242, 5, v56
    v_lshl_add_u32 v242, v57, 4, v242
    s_add_u32 s28, s27, 448
    v_add_u32 v242, s28, v242
    v_lshrrev_b32 v58, 1, v57
    v_lshl_add_u32 v58, v56, 1, v58
    v_and_b32 v59, 1, v57
    v_lshlrev_b32 v59, 3, v59
    v_lshl_add_u32 v243, v58, 6, v59
    s_lshl_b32 s28, s16, 4
    s_add_u32 s28, s28, 128384
    v_add_u32 v243, s28, v243
    v_and_b32 v58, 7, v58
    s_and_b32 s28, s30, 6
    v_xor_b32 v58, s28, v58
    v_mul_u32_u24 v59, 36864, v59
    v_lshl_add_u32 v244, v58, 4, v59
    v_lshrrev_b32 v58, 2, v56
    v_mul_u32_u24 v58, 73728, v58
    v_add_u32 v244, v244, v58
    v_lshrrev_b32 v53, 3, v78
    v_mul_u32_u24 v53, 18304, v53
    v_lshl_add_u32 v53, v78, 4, v53
    v_lshlrev_b32 v52, 4, v78
    v_lshlrev_b32 v54, 3, v65
    s_mul_i32 s53, s16, 589824
    s_lshl_b32 s20, s2, 7
    s_add_u32 s53, s53, s20
    s_lshl_b32 s55, s2, 5
    s_add_u32 s55, s55, 7176192
    s_add_u32 s56, s55, 4608
    s_lshl_b32 s57, s30, 3
    s_add_u32 s57, s57, 7185408
    s_lshl_b32 s54, s16, 12
    s_lshr_b32 s32, s30, 4
    s_mul_i32 s32, s32, 589824
    s_bfe_u32 s33, s30, 0x30001
    s_lshl_b32 s34, s33, 16
    s_add_u32 s32, s32, s34
    s_and_b32 s34, s30, 1
    s_lshl_b32 s34, s34, 12
    s_add_u32 s32, s32, s34
    s_add_u32 s32, s32, 20447232
    s_cmp_lt_u32 s30, 512
    s_cselect_b32 s34, 0, 0x80000000
    v_or_b32 v247, s34, v52
    v_mov_b32 v248, -1
    v_mov_b32 v249, -1
    v_mov_b32 v250, -1
    v_mov_b32 v251, -1
    s_lshl_b32 s52, s16, 10
    s_add_u32 s52, s52, 7208960
    s_mov_b32 s63, 0
    s_waitcnt vmcnt(7)
F_ln:
    ds_write_b32 v1, v4 offset:9472
    v_lshlrev_b32 v16, 16, v4
    v_and_b32 v17, 0xffff0000, v4
    ds_write_b32 v1, v5 offset:9600
    v_lshlrev_b32 v18, 16, v5
    v_and_b32 v19, 0xffff0000, v5
    ds_write_b32 v1, v6 offset:9728
    v_lshlrev_b32 v20, 16, v6
    v_and_b32 v21, 0xffff0000, v6
    ds_write_b32 v1, v7 offset:9856
    v_lshlrev_b32 v22, 16, v7
    v_and_b32 v23, 0xffff0000, v7
    ds_write_b32 v1, v8 offset:9984
    v_lshlrev_b32 v24, 16, v8
    v_and_b32 v25, 0xffff0000, v8
    ds_write_b32 v1, v9 offset:10112
    v_lshlrev_b32 v26, 16, v9
    v_and_b32 v27, 0xffff0000, v9
    ds_write_b32 v1, v10 offset:10240
    v_lshlrev_b32 v28, 16, v10
    v_and_b32 v29, 0xffff0000, v10
    ds_write_b32 v1, v11 offset:10368
    v_lshlrev_b32 v30, 16, v11
    v_and_b32 v31, 0xffff0000, v11
    ds_write_b32 v1, v12 offset:10496
    v_lshlrev_b32 v32, 16, v12
    v_and_b32 v33, 0xffff0000, v12
    v_add_f32 v34, v16, v17
    v_add_f32 v35, v18, v19
    v_add_f32 v34, v34, v20
    v_add_f32 v35, v35, v21
    v_add_f32 v34, v34, v22
    v_add_f32 v35, v35, v23
    v_add_f32 v34, v34, v24
    v_add_f32 v35, v35, v25
    v_add_f32 v34, v34, v26
    v_add_f32 v35, v35, v27
    v_add_f32 v34, v34, v28
    v_add_f32 v35, v35, v29
    v_add_f32 v34, v34, v30
    v_add_f32 v35, v35, v31
    v_add_f32 v34, v34, v32
    v_add_f32 v35, v35, v33
    v_add_f32 v34, v34, v35
    s_nop 1
    v_add_f32_dpp v34, v34, v34 row_ror:1 row_mask:0xf bank_mask:0xf
    s_nop 1
    v_add_f32_dpp v34, v34, v34 row_ror:2 row_mask:0xf bank_mask:0xf
    s_nop 1
    v_add_f32_dpp v34, v34, v34 row_ror:4 row_mask:0xf bank_mask:0xf
    s_nop 1
    v_add_f32_dpp v34, v34, v34 row_ror:8 row_mask:0xf bank_mask:0xf
    s_nop 1
    v_mov_b32 v35, v34
    s_nop 1
    v_permlane16_swap_b32 v34, v35
    s_nop 1
    v_add_f32 v34, v34, v35
    v_mul_f32 v34, 0x3ae38e39, v34
    v_sub_f32 v16, v16, v34
    v_sub_f32 v17, v17, v34
    v_sub_f32 v18, v18, v34
    v_sub_f32 v19, v19, v34
    v_sub_f32 v20, v20, v34
    v_sub_f32 v21, v21, v34
    v_sub_f32 v22, v22, v34
    v_sub_f32 v23, v23, v34
    v_sub_f32 v24, v24, v34
    v_sub_f32 v25, v25, v34
    v_sub_f32 v26, v26, v34
    v_sub_f32 v27, v27, v34
    v_sub_f32 v28, v28, v34
    v_sub_f32 v29, v29, v34
    v_sub_f32 v30, v30, v34
    v_sub_f32 v31, v31, v34
    v_sub_f32 v32, v32, v34
    v_sub_f32 v33, v33, v34
    v_mul_f32 v34, v16, v16
    v_mul_f32 v35, v17, v17
    v_fmac_f32 v34, v18, v18
    v_fmac_f32 v35, v19, v19
    v_fmac_f32 v34, v20, v20
    v_fmac_f32 v35, v21, v21
    v_fmac_f32 v34, v22, v22
    v_fmac_f32 v35, v23, v23
    v_fmac_f32 v34, v24, v24
    v_fmac_f32 v35, v25, v25
    v_fmac_f32 v34, v26, v26
    v_fmac_f32 v35, v27, v27
    v_fmac_f32 v34, v28, v28
    v_fmac_f32 v35, v29, v29
    v_fmac_f32 v34, v30, v30
    v_fmac_f32 v35, v31, v31
    v_fmac_f32 v34, v32, v32
    v_fmac_f32 v35, v33, v33
    v_add_f32 v34, v34, v35
    s_nop 1
    v_add_f32_dpp v34, v34, v34 row_ror:1 row_mask:0xf bank_mask:0xf
    s_nop 1
    v_add_f32_dpp v34, v34, v34 row_ror:2 row_mask:0xf bank_mask:0xf
    s_nop 1
    v_add_f32_dpp v34, v34, v34 row_ror:4 row_mask:0xf bank_mask:0xf
    s_nop 1
    v_add_f32_dpp v34, v34, v34 row_ror:8 row_mask:0xf bank_mask:0xf
    s_nop 1
    v_mov_b32 v35, v34
    s_nop 1
    v_permlane16_swap_b32 v34, v35
    s_nop 1
    v_add_f32 v34, v34, v35
    v_mov_b32 v35, 0x3727c5ac
    v_fmac_f32 v35, 0x3ae38e39, v34
    v_rsq_f32 v34, v35
    s_nop 0
    v_mul_f32 v16, v16, v34
    v_mul_f32 v17, v17, v34
    v_mul_f32 v18, v18, v34
    v_mul_f32 v19, v19, v34
    v_mul_f32 v20, v20, v34
    v_mul_f32 v21, v21, v34
    v_mul_f32 v22, v22, v34
    v_mul_f32 v23, v23, v34
    v_mul_f32 v24, v24, v34
    v_mul_f32 v25, v25, v34
    v_mul_f32 v26, v26, v34
    v_mul_f32 v27, v27, v34
    v_mul_f32 v28, v28, v34
    v_mul_f32 v29, v29, v34
    v_mul_f32 v30, v30, v34
    v_mul_f32 v31, v31, v34
    v_mul_f32 v32, v32, v34
    v_mul_f32 v33, v33, v34
    v_cvt_pk_bf16_f32 v4, v16, v17
    ds_write_b32 v1, v4 offset:0
    v_cvt_pk_bf16_f32 v5, v18, v19
    ds_write_b32 v1, v5 offset:128
    v_cvt_pk_bf16_f32 v6, v20, v21
    ds_write_b32 v1, v6 offset:256
    v_cvt_pk_bf16_f32 v7, v22, v23
    ds_write_b32 v1, v7 offset:384
    v_cvt_pk_bf16_f32 v8, v24, v25
    ds_write_b32 v1, v8 offset:512
    v_cvt_pk_bf16_f32 v9, v26, v27
    ds_write_b32 v1, v9 offset:640
    v_cvt_pk_bf16_f32 v10, v28, v29
    ds_write_b32 v1, v10 offset:768
    v_cvt_pk_bf16_f32 v11, v30, v31
    ds_write_b32 v1, v11 offset:896
    v_cvt_pk_bf16_f32 v12, v32, v33
    ds_write_b32 v1, v12 offset:1024
    v_and_b32 v43, 63, v0
    v_bfe_u32 v36, v43, 2, 2
    v_bfe_u32 v37, v43, 4, 1
    v_lshrrev_b32 v39, 5, v43
    v_and_b32 v40, 3, v0
    s_lshl_b32 s18, s16, 1
    v_add_u32 v39, s18, v39
    v_lshl_add_u32 v38, v39, 2, v36
    v_lshlrev_b32 v38, 7, v38
    v_mul_u32_u24 v41, 0x240000, v37
    v_add_u32 v38, v41, v38
    v_lshl_add_u32 v38, v40, 4, v38
    v_lshl_add_u32 v36, v37, 3, v36
    v_mul_u32_u24 v36, 1184, v36
    v_lshl_add_u32 v36, v39, 5, v36
    v_lshl_add_u32 v36, v40, 3, v36
    v_add_u32 v36, 128384, v36
    s_and_b32 s18, s2, 1
    s_mul_i32 s18, s18, 9152
    s_sub_u32 s17, s17, s18
    s_cmp_lt_u32 s16, 2
    s_cselect_b32 s18, 0, 0x80000000
    v_or_b32 v41, s18, v38
    s_lshl_b32 s42, s2, 4
    s_lshl_b32 s18, s16, 2
    s_add_u32 s42, s42, s18
    s_add_u32 s42, s42, 7208960
    s_waitcnt lgkmcnt(0)
    s_barrier
    ds_read_b64_tr_b16 v[16:17], v36 offset:0
    ds_read_b64_tr_b16 v[18:19], v36 offset:4736
    ds_read_b64_tr_b16 v[20:21], v36 offset:256
    ds_read_b64_tr_b16 v[22:23], v36 offset:4992
    ds_read_b64_tr_b16 v[24:25], v36 offset:512
    ds_read_b64_tr_b16 v[26:27], v36 offset:5248
    ds_read_b64_tr_b16 v[28:29], v36 offset:768
    ds_read_b64_tr_b16 v[30:31], v36 offset:5504
    ds_read_b64_tr_b16 v[32:33], v36 offset:1024
    ds_read_b64_tr_b16 v[34:35], v36 offset:5760
    s_waitcnt lgkmcnt(8)
    buffer_store_dwordx4 v[16:19], v38, s[12:15], s17 offen sc1
    s_add_u32 s17, s17, 4096
    s_waitcnt lgkmcnt(6)
    buffer_store_dwordx4 v[20:23], v38, s[12:15], s17 offen sc1
    s_add_u32 s17, s17, 4096
    s_waitcnt lgkmcnt(4)
    buffer_store_dwordx4 v[24:27], v38, s[12:15], s17 offen sc1
    s_add_u32 s17, s17, 4096
    s_waitcnt lgkmcnt(2)
    buffer_store_dwordx4 v[28:31], v38, s[12:15], s17 offen sc1
    s_add_u32 s17, s17, 4096
    s_waitcnt lgkmcnt(0)
    buffer_store_dwordx4 v[32:35], v41, s[12:15], s17 offen sc1
    s_add_u32 s17, s17, 4096
    v_mov_b32 v44, 0
    v_lshlrev_b32 v45, 2, v0
    v_cmp_gt_u32 vcc, 32, v0
    v_mov_b32 v46, 0x80000000
    s_lshl_b32 s18, s2, 7
    s_add_u32 s18, s18, 39321600
    v_cndmask_b32 v45, v46, v45, vcc
    buffer_store_dword v44, v45, s[12:15], s18 offen sc1
    v_mov_b32 v63, 0
    s_add_u32 s40, s40, 0x9e3779b1
    v_mov_b32 v62, s40
    s_cmp_eq_u32 s63, 1
    s_cbranch_scc1 F_hp2
    v_mov_b32 v0, v78
    v_lshl_add_u32 v2, v0, 3, s23
    s_waitcnt vmcnt(7)
    v_lshlrev_b32 v68, 16, v68
    v_mul_f32 v68, 0x3fb8aa3b, v68
    v_exp_f32 v68, v68
    v_and_b32 v71, 0xffff0000, v70
    v_lshlrev_b32 v70, 16, v70
    v_and_b32 v73, 0xffff0000, v72
    v_lshlrev_b32 v72, 16, v72
    v_and_b32 v75, 0xffff0000, v74
    v_lshlrev_b32 v74, 16, v74
    v_and_b32 v77, 0xffff0000, v76
    v_lshlrev_b32 v76, 16, v76
    v_mul_f32 v70, 0x3fb8aa3b, v70
    v_mul_f32 v71, 0x3fb8aa3b, v71
    v_exp_f32 v70, v70
    v_exp_f32 v71, v71
    v_lshlrev_b32 v69, 16, v69
    v_cvt_pk_bf16_f32 v68, v68, v68
    v_and_b32 v68, 0xffff0000, v68
    v_cvt_pk_bf16_f32 v70, v70, v70
    v_and_b32 v70, 0xffff0000, v70
    v_cvt_pk_bf16_f32 v71, v71, v71
    v_and_b32 v71, 0xffff0000, v71
    v_mul_f32 v70, v70, v68
    v_mul_f32 v71, v71, v68
    v_mul_f32 v72, v72, v68
    v_mul_f32 v73, v73, v68
    v_add_f32 v68, v68, v68
    v_mul_f32 v70, 0xbfb8aa3b, v70
    v_mul_f32 v72, 0.15915494, v72
    v_mul_f32 v71, 0xbfb8aa3b, v71
    v_mul_f32 v73, 0.15915494, v73
    v_mul_f32 v120, v74, v68
    v_mul_f32 v121, v75, v68
    v_mul_f32 v122, v76, v68
    v_mul_f32 v123, v77, v68
    v_mul_f32 v84, 0x41000000, v70
    v_mul_f32 v128, 1.0, v70
    v_mul_f32 v86, 0x41000000, v72
    v_mul_f32 v130, 1.0, v72
    v_mul_f32 v85, 0x41000000, v71
    v_mul_f32 v129, 1.0, v71
    v_mul_f32 v87, 0x41000000, v73
    v_mul_f32 v131, 1.0, v73
    v_exp_f32 v84, v84
    v_exp_f32 v128, v128
    v_fract_f32 v86, v86
    v_fract_f32 v130, v130
    v_exp_f32 v85, v85
    v_exp_f32 v129, v129
    v_fract_f32 v87, v87
    v_fract_f32 v131, v131
    v_cos_f32 v80, v86
    v_cos_f32 v100, v130
    v_sin_f32 v82, v86
    v_sin_f32 v102, v130
    v_cos_f32 v81, v87
    v_cos_f32 v101, v131
    v_sin_f32 v83, v87
    v_sin_f32 v103, v131
    s_nop 0
    s_nop 0
    v_pk_mul_f32 v[80:81], v[80:81], v[84:85]
    v_pk_mul_f32 v[100:101], v[100:101], v[128:129]
    v_pk_mul_f32 v[82:83], v[82:83], v[84:85]
    v_pk_mul_f32 v[102:103], v[102:103], v[128:129]
    v_mov_b32 v96, 0x3f803f80
    v_mul_f32 v132, 0x43800000, v70
    v_mov_b32 v97, 0
    v_mul_f32 v134, 0x43800000, v72
    ds_write_b64 v2, v[96:97] offset:14688
    v_mul_f32 v133, 0x43800000, v71
    v_cvt_pk_bf16_f32 v94, v80, v81
    v_mul_f32 v135, 0x43800000, v73
    v_cvt_pk_bf16_f32 v95, v82, v83
    v_exp_f32 v132, v132
    ds_write_b64 v2, v[94:95] offset:15232
    v_fract_f32 v134, v134
    v_pk_mul_f32 v[92:93], v[82:83], v[82:83]
    v_exp_f32 v133, v133
    v_pk_mul_f32 v[86:87], v[82:83], v[80:81]
    v_fract_f32 v135, v135
    v_pk_fma_f32 v[84:85], v[80:81], v[80:81], v[92:93] neg_lo:[0,0,1] neg_hi:[0,0,1]
    v_cos_f32 v116, v134
    v_pk_fma_f32 v[86:87], v[80:81], v[82:83], v[86:87]
    v_sin_f32 v118, v134
    v_cvt_pk_bf16_f32 v96, v84, v85
    v_cos_f32 v117, v135
    v_cvt_pk_bf16_f32 v97, v86, v87
    v_sin_f32 v119, v135
    ds_write_b64 v2, v[96:97] offset:15776
    s_nop 0
    v_pk_mul_f32 v[92:93], v[86:87], v[82:83]
    v_pk_mul_f32 v[116:117], v[116:117], v[132:133]
    v_pk_mul_f32 v[90:91], v[86:87], v[80:81]
    v_pk_mul_f32 v[118:119], v[118:119], v[132:133]
    v_pk_fma_f32 v[88:89], v[84:85], v[80:81], v[92:93] neg_lo:[0,0,1] neg_hi:[0,0,1]
    v_pk_mul_f32 v[136:137], v[102:103], v[102:103]
    v_pk_fma_f32 v[90:91], v[84:85], v[82:83], v[90:91]
    v_pk_mul_f32 v[106:107], v[102:103], v[100:101]
    v_cvt_pk_bf16_f32 v94, v88, v89
    v_pk_fma_f32 v[104:105], v[100:101], v[100:101], v[136:137] neg_lo:[0,0,1] neg_hi:[0,0,1]
    v_cvt_pk_bf16_f32 v95, v90, v91
    v_pk_fma_f32 v[106:107], v[100:101], v[102:103], v[106:107]
    ds_write_b64 v2, v[94:95] offset:16320
    v_pk_mul_f32 v[136:137], v[106:107], v[106:107]
    v_pk_mul_f32 v[92:93], v[90:91], v[82:83]
    v_pk_mul_f32 v[110:111], v[106:107], v[104:105]
    v_pk_mul_f32 v[86:87], v[90:91], v[80:81]
    v_pk_fma_f32 v[108:109], v[104:105], v[104:105], v[136:137] neg_lo:[0,0,1] neg_hi:[0,0,1]
    v_pk_fma_f32 v[84:85], v[88:89], v[80:81], v[92:93] neg_lo:[0,0,1] neg_hi:[0,0,1]
    v_pk_fma_f32 v[110:111], v[104:105], v[106:107], v[110:111]
    v_pk_fma_f32 v[86:87], v[88:89], v[82:83], v[86:87]
    v_pk_mul_f32 v[136:137], v[110:111], v[110:111]
    v_cvt_pk_bf16_f32 v96, v84, v85
    v_pk_mul_f32 v[114:115], v[110:111], v[108:109]
    v_cvt_pk_bf16_f32 v97, v86, v87
    v_pk_fma_f32 v[112:113], v[108:109], v[108:109], v[136:137] neg_lo:[0,0,1] neg_hi:[0,0,1]
    ds_write_b64 v2, v[96:97] offset:16864
    v_pk_fma_f32 v[114:115], v[108:109], v[110:111], v[114:115]
    v_pk_mul_f32 v[92:93], v[86:87], v[82:83]
    v_cvt_pk_bf16_f32 v138, v120, v121
    v_pk_mul_f32 v[90:91], v[86:87], v[80:81]
    v_cvt_pk_bf16_f32 v139, -v122, -v123
    v_pk_fma_f32 v[88:89], v[84:85], v[80:81], v[92:93] neg_lo:[0,0,1] neg_hi:[0,0,1]
    ds_write_b64 v2, v[138:139] offset:0
    v_pk_fma_f32 v[90:91], v[84:85], v[82:83], v[90:91]
    v_pk_mul_f32 v[136:137], v[122:123], v[102:103]
    v_cvt_pk_bf16_f32 v94, v88, v89
    v_pk_mul_f32 v[130:131], v[122:123], v[100:101]
    v_cvt_pk_bf16_f32 v95, v90, v91
    v_pk_fma_f32 v[128:129], v[120:121], v[100:101], v[136:137] neg_lo:[0,0,1] neg_hi:[0,0,1]
    ds_write_b64 v2, v[94:95] offset:17408
    v_pk_fma_f32 v[130:131], v[120:121], v[102:103], v[130:131]
    v_pk_mul_f32 v[92:93], v[90:91], v[82:83]
    v_cvt_pk_bf16_f32 v140, v128, v129
    v_pk_mul_f32 v[86:87], v[90:91], v[80:81]
    v_cvt_pk_bf16_f32 v141, -v130, -v131
    v_pk_fma_f32 v[84:85], v[88:89], v[80:81], v[92:93] neg_lo:[0,0,1] neg_hi:[0,0,1]
    ds_write_b64 v2, v[140:141] offset:544
    v_pk_fma_f32 v[86:87], v[88:89], v[82:83], v[86:87]
    v_pk_mul_f32 v[136:137], v[130:131], v[102:103]
    v_cvt_pk_bf16_f32 v96, v84, v85
    v_pk_mul_f32 v[134:135], v[130:131], v[100:101]
    v_cvt_pk_bf16_f32 v97, v86, v87
    v_pk_fma_f32 v[132:133], v[128:129], v[100:101], v[136:137] neg_lo:[0,0,1] neg_hi:[0,0,1]
    ds_write_b64 v2, v[96:97] offset:17952
    v_pk_fma_f32 v[134:135], v[128:129], v[102:103], v[134:135]
    v_pk_mul_f32 v[92:93], v[86:87], v[82:83]
    v_cvt_pk_bf16_f32 v138, v132, v133
    v_pk_mul_f32 v[90:91], v[86:87], v[80:81]
    v_cvt_pk_bf16_f32 v139, -v134, -v135
    v_pk_fma_f32 v[88:89], v[84:85], v[80:81], v[92:93] neg_lo:[0,0,1] neg_hi:[0,0,1]
    ds_write_b64 v2, v[138:139] offset:1088
    v_pk_fma_f32 v[90:91], v[84:85], v[82:83], v[90:91]
    v_pk_mul_f32 v[136:137], v[134:135], v[102:103]
    v_cvt_pk_bf16_f32 v94, v88, v89
    v_pk_mul_f32 v[130:131], v[134:135], v[100:101]
    v_cvt_pk_bf16_f32 v95, v90, v91
    v_pk_fma_f32 v[128:129], v[132:133], v[100:101], v[136:137] neg_lo:[0,0,1] neg_hi:[0,0,1]
    ds_write_b64 v2, v[94:95] offset:18496
    v_pk_fma_f32 v[130:131], v[132:133], v[102:103], v[130:131]
    v_pk_mul_f32 v[92:93], v[90:91], v[82:83]
    v_cvt_pk_bf16_f32 v140, v128, v129
    v_pk_mul_f32 v[86:87], v[90:91], v[80:81]
    v_cvt_pk_bf16_f32 v141, -v130, -v131
    v_pk_fma_f32 v[84:85], v[88:89], v[80:81], v[92:93] neg_lo:[0,0,1] neg_hi:[0,0,1]
    ds_write_b64 v2, v[140:141] offset:1632
    v_pk_fma_f32 v[86:87], v[88:89], v[82:83], v[86:87]
    v_pk_mul_f32 v[136:137], v[130:131], v[102:103]
    v_cvt_pk_bf16_f32 v96, v84, v85
    v_pk_mul_f32 v[134:135], v[130:131], v[100:101]
    v_cvt_pk_bf16_f32 v97, v86, v87
    v_pk_fma_f32 v[132:133], v[128:129], v[100:101], v[136:137] neg_lo:[0,0,1] neg_hi:[0,0,1]
    ds_write_b64 v2, v[96:97] offset:19040
    v_pk_fma_f32 v[134:135], v[128:129], v[102:103], v[134:135]
    v_pk_mul_f32 v[92:93], v[86:87], v[82:83]
    v_cvt_pk_bf16_f32 v138, v132, v133
    v_pk_mul_f32 v[90:91], v[86:87], v[80:81]
    v_cvt_pk_bf16_f32 v139, -v134, -v135
    v_pk_fma_f32 v[88:89], v[84:85], v[80:81], v[92:93] neg_lo:[0,0,1] neg_hi:[0,0,1]
    ds_write_b64 v2, v[138:139] offset:2176
    v_pk_fma_f32 v[90:91], v[84:85], v[82:83], v[90:91]
    v_pk_mul_f32 v[136:137], v[134:135], v[102:103]
    v_cvt_pk_bf16_f32 v94, v88, v89
    v_pk_mul_f32 v[130:131], v[134:135], v[100:101]
    v_cvt_pk_bf16_f32 v95, v90, v91
    v_pk_fma_f32 v[128:129], v[132:133], v[100:101], v[136:137] neg_lo:[0,0,1] neg_hi:[0,0,1]
    ds_write_b64 v2, v[94:95] offset:19584
    v_pk_fma_f32 v[130:131], v[132:133], v[102:103], v[130:131]
    v_pk_mul_f32 v[92:93], v[90:91], v[82:83]
    v_cvt_pk_bf16_f32 v140, v128, v129
    v_pk_mul_f32 v[86:87], v[90:91], v[80:81]
    v_cvt_pk_bf16_f32 v141, -v130, -v131
    v_pk_fma_f32 v[84:85], v[88:89], v[80:81], v[92:93] neg_lo:[0,0,1] neg_hi:[0,0,1]
    ds_write_b64 v2, v[140:141] offset:2720
    v_pk_fma_f32 v[86:87], v[88:89], v[82:83], v[86:87]
    v_pk_mul_f32 v[136:137], v[130:131], v[102:103]
    v_cvt_pk_bf16_f32 v96, v84, v85
    v_pk_mul_f32 v[134:135], v[130:131], v[100:101]
    v_cvt_pk_bf16_f32 v97, v86, v87
    v_pk_fma_f32 v[132:133], v[128:129], v[100:101], v[136:137] neg_lo:[0,0,1] neg_hi:[0,0,1]
    ds_write_b64 v2, v[96:97] offset:20128
    v_pk_fma_f32 v[134:135], v[128:129], v[102:103], v[134:135]
    v_pk_mul_f32 v[92:93], v[86:87], v[82:83]
    v_cvt_pk_bf16_f32 v138, v132, v133
    v_pk_mul_f32 v[90:91], v[86:87], v[80:81]
    v_cvt_pk_bf16_f32 v139, -v134, -v135
    v_pk_fma_f32 v[88:89], v[84:85], v[80:81], v[92:93] neg_lo:[0,0,1] neg_hi:[0,0,1]
    ds_write_b64 v2, v[138:139] offset:3264
    v_pk_fma_f32 v[90:91], v[84:85], v[82:83], v[90:91]
    v_pk_mul_f32 v[136:137], v[134:135], v[102:103]
    v_cvt_pk_bf16_f32 v94, v88, v89
    v_pk_mul_f32 v[130:131], v[134:135], v[100:101]
    v_cvt_pk_bf16_f32 v95, v90, v91
    v_pk_fma_f32 v[128:129], v[132:133], v[100:101], v[136:137] neg_lo:[0,0,1] neg_hi:[0,0,1]
    ds_write_b64 v2, v[94:95] offset:20672
    v_pk_fma_f32 v[130:131], v[132:133], v[102:103], v[130:131]
    v_pk_mul_f32 v[92:93], v[90:91], v[82:83]
    v_cvt_pk_bf16_f32 v140, v128, v129
    v_pk_mul_f32 v[86:87], v[90:91], v[80:81]
    v_cvt_pk_bf16_f32 v141, -v130, -v131
    v_pk_fma_f32 v[84:85], v[88:89], v[80:81], v[92:93] neg_lo:[0,0,1] neg_hi:[0,0,1]
    ds_write_b64 v2, v[140:141] offset:3808
    v_pk_fma_f32 v[86:87], v[88:89], v[82:83], v[86:87]
    v_pk_mul_f32 v[136:137], v[122:123], v[118:119]
    v_cvt_pk_bf16_f32 v96, v84, v85
    v_pk_mul_f32 v[126:127], v[122:123], v[116:117]
    v_cvt_pk_bf16_f32 v97, v86, v87
    v_pk_fma_f32 v[124:125], v[120:121], v[116:117], v[136:137] neg_lo:[0,0,1] neg_hi:[0,0,1]
    ds_write_b64 v2, v[96:97] offset:21216
    v_pk_fma_f32 v[126:127], v[120:121], v[118:119], v[126:127]
    v_pk_mul_f32 v[92:93], v[86:87], v[82:83]
    v_cvt_pk_bf16_f32 v138, v124, v125
    v_pk_mul_f32 v[90:91], v[86:87], v[80:81]
    v_cvt_pk_bf16_f32 v139, -v126, -v127
    v_pk_fma_f32 v[88:89], v[84:85], v[80:81], v[92:93] neg_lo:[0,0,1] neg_hi:[0,0,1]
    ds_write_b64 v2, v[138:139] offset:4352
    v_pk_fma_f32 v[90:91], v[84:85], v[82:83], v[90:91]
    v_pk_mul_f32 v[136:137], v[126:127], v[106:107]
    v_cvt_pk_bf16_f32 v94, v88, v89
    v_pk_mul_f32 v[130:131], v[126:127], v[104:105]
    v_cvt_pk_bf16_f32 v95, v90, v91
    v_pk_fma_f32 v[128:129], v[124:125], v[104:105], v[136:137] neg_lo:[0,0,1] neg_hi:[0,0,1]
    ds_write_b64 v2, v[94:95] offset:21760
    v_pk_fma_f32 v[130:131], v[124:125], v[106:107], v[130:131]
    v_pk_mul_f32 v[92:93], v[90:91], v[82:83]
    v_cvt_pk_bf16_f32 v140, v128, v129
    v_pk_mul_f32 v[86:87], v[90:91], v[80:81]
    v_cvt_pk_bf16_f32 v141, -v130, -v131
    v_pk_fma_f32 v[84:85], v[88:89], v[80:81], v[92:93] neg_lo:[0,0,1] neg_hi:[0,0,1]
    ds_write_b64 v2, v[140:141] offset:4896
    v_pk_fma_f32 v[86:87], v[88:89], v[82:83], v[86:87]
    v_pk_mul_f32 v[136:137], v[130:131], v[106:107]
    v_cvt_pk_bf16_f32 v96, v84, v85
    v_pk_mul_f32 v[134:135], v[130:131], v[104:105]
    v_cvt_pk_bf16_f32 v97, v86, v87
    v_pk_fma_f32 v[132:133], v[128:129], v[104:105], v[136:137] neg_lo:[0,0,1] neg_hi:[0,0,1]
    ds_write_b64 v2, v[96:97] offset:22304
    v_pk_fma_f32 v[134:135], v[128:129], v[106:107], v[134:135]
    v_pk_mul_f32 v[92:93], v[86:87], v[82:83]
    v_cvt_pk_bf16_f32 v138, v132, v133
    v_pk_mul_f32 v[90:91], v[86:87], v[80:81]
    v_cvt_pk_bf16_f32 v139, -v134, -v135
    v_pk_fma_f32 v[88:89], v[84:85], v[80:81], v[92:93] neg_lo:[0,0,1] neg_hi:[0,0,1]
    ds_write_b64 v2, v[138:139] offset:5440
    v_pk_fma_f32 v[90:91], v[84:85], v[82:83], v[90:91]
    v_pk_mul_f32 v[136:137], v[134:135], v[106:107]
    v_cvt_pk_bf16_f32 v94, v88, v89
    v_pk_mul_f32 v[130:131], v[134:135], v[104:105]
    v_cvt_pk_bf16_f32 v95, v90, v91
    v_pk_fma_f32 v[128:129], v[132:133], v[104:105], v[136:137] neg_lo:[0,0,1] neg_hi:[0,0,1]
    ds_write_b64 v2, v[94:95] offset:22848
    v_pk_fma_f32 v[130:131], v[132:133], v[106:107], v[130:131]
    v_pk_mul_f32 v[92:93], v[90:91], v[82:83]
    v_cvt_pk_bf16_f32 v140, v128, v129
    v_pk_mul_f32 v[86:87], v[90:91], v[80:81]
    v_cvt_pk_bf16_f32 v141, -v130, -v131
    v_pk_fma_f32 v[84:85], v[88:89], v[80:81], v[92:93] neg_lo:[0,0,1] neg_hi:[0,0,1]
    ds_write_b64 v2, v[140:141] offset:5984
    v_pk_fma_f32 v[86:87], v[88:89], v[82:83], v[86:87]
    v_pk_mul_f32 v[136:137], v[130:131], v[106:107]
    v_cvt_pk_bf16_f32 v96, v84, v85
    v_pk_mul_f32 v[134:135], v[130:131], v[104:105]
    v_cvt_pk_bf16_f32 v97, v86, v87
    v_pk_fma_f32 v[132:133], v[128:129], v[104:105], v[136:137] neg_lo:[0,0,1] neg_hi:[0,0,1]
    ds_write_b64 v2, v[96:97] offset:23392
    v_pk_fma_f32 v[134:135], v[128:129], v[106:107], v[134:135]
    v_pk_mul_f32 v[92:93], v[86:87], v[82:83]
    v_cvt_pk_bf16_f32 v138, v132, v133
    v_pk_mul_f32 v[90:91], v[86:87], v[80:81]
    v_cvt_pk_bf16_f32 v139, -v134, -v135
    v_pk_fma_f32 v[88:89], v[84:85], v[80:81], v[92:93] neg_lo:[0,0,1] neg_hi:[0,0,1]
    ds_write_b64 v2, v[138:139] offset:6528
    v_pk_fma_f32 v[90:91], v[84:85], v[82:83], v[90:91]
    v_pk_mul_f32 v[136:137], v[126:127], v[118:119]
    v_cvt_pk_bf16_f32 v94, v88, v89
    v_pk_mul_f32 v[122:123], v[126:127], v[116:117]
    v_cvt_pk_bf16_f32 v95, v90, v91
    v_pk_fma_f32 v[120:121], v[124:125], v[116:117], v[136:137] neg_lo:[0,0,1] neg_hi:[0,0,1]
    ds_write_b64 v2, v[94:95] offset:23936
    v_pk_fma_f32 v[122:123], v[124:125], v[118:119], v[122:123]
    v_pk_mul_f32 v[92:93], v[90:91], v[82:83]
    v_cvt_pk_bf16_f32 v140, v120, v121
    v_pk_mul_f32 v[86:87], v[90:91], v[80:81]
    v_cvt_pk_bf16_f32 v141, -v122, -v123
    v_pk_fma_f32 v[84:85], v[88:89], v[80:81], v[92:93] neg_lo:[0,0,1] neg_hi:[0,0,1]
    ds_write_b64 v2, v[140:141] offset:7072
    v_pk_fma_f32 v[86:87], v[88:89], v[82:83], v[86:87]
    v_pk_mul_f32 v[136:137], v[122:123], v[110:111]
    s_waitcnt vmcnt(0)
    s_mov_b64 exec, 1
    buffer_store_dword v62, v63, s[12:15], s42 offen sc1
    s_mov_b64 exec, -1
    s_and_b32 s19, s2, 7
    s_lshr_b32 s20, s2, 3
    s_lshl_b32 s20, s20, 2
    s_add_u32 s20, s20, s16
    s_mul_i32 s21, s19, 663552
    s_mul_i32 s22, s20, 9216
    s_add_u32 s21, s21, s22
    v_lshl_add_u32 v48, v0, 7, s21
    s_mul_i32 s21, s19, 1152
    s_lshl_b32 s22, s22, 3
    s_add_u32 s21, s21, s22
    v_lshrrev_b32 v49, 3, v0
    v_and_b32 v50, 7, v0
    v_mul_u32_u24 v49, 9216, v49
    v_lshl_add_u32 v49, v50, 7, v49
    v_add_u32 v49, s21, v49
    v_mul_u32_u24 v50, 9216, v50
    v_add_u32 v50, s21, v50
    v_add_u32 v51, 8192, v48
    global_load_dword v48, v48, s[46:47]
    global_load_dword v49, v49, s[44:45]
    s_mov_b64 exec, 0xff
    global_load_dword v51, v51, s[46:47]
    global_load_dword v50, v50, s[44:45] offset:1024
    s_mov_b64 exec, -1
    s_barrier
    v_cvt_pk_bf16_f32 v96, v84, v85
    v_pk_mul_f32 v[130:131], v[122:123], v[108:109]
    v_cvt_pk_bf16_f32 v97, v86, v87
    v_pk_fma_f32 v[128:129], v[120:121], v[108:109], v[136:137] neg_lo:[0,0,1] neg_hi:[0,0,1]
    ds_write_b64 v2, v[96:97] offset:24480
    v_pk_fma_f32 v[130:131], v[120:121], v[110:111], v[130:131]
    v_pk_mul_f32 v[92:93], v[86:87], v[82:83]
    v_cvt_pk_bf16_f32 v138, v128, v129
    v_pk_mul_f32 v[90:91], v[86:87], v[80:81]
    v_cvt_pk_bf16_f32 v139, -v130, -v131
    v_pk_fma_f32 v[88:89], v[84:85], v[80:81], v[92:93] neg_lo:[0,0,1] neg_hi:[0,0,1]
    ds_write_b64 v2, v[138:139] offset:7616
    v_pk_fma_f32 v[90:91], v[84:85], v[82:83], v[90:91]
    v_pk_mul_f32 v[136:137], v[130:131], v[110:111]
    v_cvt_pk_bf16_f32 v94, v88, v89
    v_pk_mul_f32 v[134:135], v[130:131], v[108:109]
    v_cvt_pk_bf16_f32 v95, v90, v91
    v_pk_fma_f32 v[132:133], v[128:129], v[108:109], v[136:137] neg_lo:[0,0,1] neg_hi:[0,0,1]
    ds_write_b64 v2, v[94:95] offset:25024
    v_pk_fma_f32 v[134:135], v[128:129], v[110:111], v[134:135]
    v_pk_mul_f32 v[92:93], v[90:91], v[82:83]
    v_cvt_pk_bf16_f32 v140, v132, v133
    v_pk_mul_f32 v[86:87], v[90:91], v[80:81]
    v_cvt_pk_bf16_f32 v141, -v134, -v135
    v_pk_fma_f32 v[84:85], v[88:89], v[80:81], v[92:93] neg_lo:[0,0,1] neg_hi:[0,0,1]
    ds_write_b64 v2, v[140:141] offset:8160
    v_pk_fma_f32 v[86:87], v[88:89], v[82:83], v[86:87]
    v_pk_mul_f32 v[136:137], v[122:123], v[118:119]
    v_cvt_pk_bf16_f32 v96, v84, v85
    v_pk_mul_f32 v[126:127], v[122:123], v[116:117]
    v_cvt_pk_bf16_f32 v97, v86, v87
    v_pk_fma_f32 v[124:125], v[120:121], v[116:117], v[136:137] neg_lo:[0,0,1] neg_hi:[0,0,1]
    ds_write_b64 v2, v[96:97] offset:25568
    v_pk_fma_f32 v[126:127], v[120:121], v[118:119], v[126:127]
    v_pk_mul_f32 v[92:93], v[86:87], v[82:83]
    v_cvt_pk_bf16_f32 v138, v124, v125
    v_pk_mul_f32 v[90:91], v[86:87], v[80:81]
    v_cvt_pk_bf16_f32 v139, -v126, -v127
    v_pk_fma_f32 v[88:89], v[84:85], v[80:81], v[92:93] neg_lo:[0,0,1] neg_hi:[0,0,1]
    ds_write_b64 v2, v[138:139] offset:8704
    v_pk_fma_f32 v[90:91], v[84:85], v[82:83], v[90:91]
    v_pk_mul_f32 v[136:137], v[126:127], v[110:111]
    v_cvt_pk_bf16_f32 v94, v88, v89
    v_pk_mul_f32 v[130:131], v[126:127], v[108:109]
    v_cvt_pk_bf16_f32 v95, v90, v91
    v_pk_fma_f32 v[128:129], v[124:125], v[108:109], v[136:137] neg_lo:[0,0,1] neg_hi:[0,0,1]
    ds_write_b64 v2, v[94:95] offset:26112
    v_pk_fma_f32 v[130:131], v[124:125], v[110:111], v[130:131]
    v_pk_mul_f32 v[92:93], v[90:91], v[82:83]
    v_cvt_pk_bf16_f32 v140, v128, v129
    v_pk_mul_f32 v[86:87], v[90:91], v[80:81]
    v_cvt_pk_bf16_f32 v141, -v130, -v131
    v_pk_fma_f32 v[84:85], v[88:89], v[80:81], v[92:93] neg_lo:[0,0,1] neg_hi:[0,0,1]
    ds_write_b64 v2, v[140:141] offset:9248
    v_pk_fma_f32 v[86:87], v[88:89], v[82:83], v[86:87]
    v_pk_mul_f32 v[136:137], v[130:131], v[110:111]
    v_cvt_pk_bf16_f32 v96, v84, v85
    v_pk_mul_f32 v[134:135], v[130:131], v[108:109]
    v_cvt_pk_bf16_f32 v97, v86, v87
    v_pk_fma_f32 v[132:133], v[128:129], v[108:109], v[136:137] neg_lo:[0,0,1] neg_hi:[0,0,1]
    ds_write_b64 v2, v[96:97] offset:26656
    v_pk_fma_f32 v[134:135], v[128:129], v[110:111], v[134:135]
    v_pk_mul_f32 v[92:93], v[86:87], v[82:83]
    v_cvt_pk_bf16_f32 v138, v132, v133
    v_pk_mul_f32 v[90:91], v[86:87], v[80:81]
    v_cvt_pk_bf16_f32 v139, -v134, -v135
    v_pk_fma_f32 v[88:89], v[84:85], v[80:81], v[92:93] neg_lo:[0,0,1] neg_hi:[0,0,1]
    ds_write_b64 v2, v[138:139] offset:9792
    v_pk_fma_f32 v[90:91], v[84:85], v[82:83], v[90:91]
    v_pk_mul_f32 v[136:137], v[126:127], v[118:119]
    v_cvt_pk_bf16_f32 v94, v88, v89
    v_pk_mul_f32 v[122:123], v[126:127], v[116:117]
    v_cvt_pk_bf16_f32 v95, v90, v91
    v_pk_fma_f32 v[120:121], v[124:125], v[116:117], v[136:137] neg_lo:[0,0,1] neg_hi:[0,0,1]
    ds_write_b64 v2, v[94:95] offset:27200
    v_pk_fma_f32 v[122:123], v[124:125], v[118:119], v[122:123]
    v_pk_mul_f32 v[92:93], v[90:91], v[82:83]
    v_cvt_pk_bf16_f32 v140, v120, v121
    v_pk_mul_f32 v[86:87], v[90:91], v[80:81]
    v_cvt_pk_bf16_f32 v141, -v122, -v123
    v_pk_fma_f32 v[84:85], v[88:89], v[80:81], v[92:93] neg_lo:[0,0,1] neg_hi:[0,0,1]
    ds_write_b64 v2, v[140:141] offset:10336
    v_pk_fma_f32 v[86:87], v[88:89], v[82:83], v[86:87]
    v_pk_mul_f32 v[136:137], v[122:123], v[114:115]
    v_cvt_pk_bf16_f32 v96, v84, v85
    v_pk_mul_f32 v[130:131], v[122:123], v[112:113]
    v_cvt_pk_bf16_f32 v97, v86, v87
    v_pk_fma_f32 v[128:129], v[120:121], v[112:113], v[136:137] neg_lo:[0,0,1] neg_hi:[0,0,1]
    ds_write_b64 v2, v[96:97] offset:27744
    v_pk_fma_f32 v[130:131], v[120:121], v[114:115], v[130:131]
    v_pk_mul_f32 v[92:93], v[86:87], v[82:83]
    v_cvt_pk_bf16_f32 v138, v128, v129
    v_pk_mul_f32 v[90:91], v[86:87], v[80:81]
    v_cvt_pk_bf16_f32 v139, -v130, -v131
    v_pk_fma_f32 v[88:89], v[84:85], v[80:81], v[92:93] neg_lo:[0,0,1] neg_hi:[0,0,1]
    ds_write_b64 v2, v[138:139] offset:10880
    v_pk_fma_f32 v[90:91], v[84:85], v[82:83], v[90:91]
    v_pk_mul_f32 v[136:137], v[122:123], v[118:119]
    v_cvt_pk_bf16_f32 v94, v88, v89
    v_pk_mul_f32 v[126:127], v[122:123], v[116:117]
    v_cvt_pk_bf16_f32 v95, v90, v91
    v_pk_fma_f32 v[124:125], v[120:121], v[116:117], v[136:137] neg_lo:[0,0,1] neg_hi:[0,0,1]
    ds_write_b64 v2, v[94:95] offset:28288
    v_pk_fma_f32 v[126:127], v[120:121], v[118:119], v[126:127]
    v_pk_mul_f32 v[92:93], v[90:91], v[82:83]
    v_cvt_pk_bf16_f32 v140, v124, v125
    v_pk_mul_f32 v[86:87], v[90:91], v[80:81]
    v_cvt_pk_bf16_f32 v141, -v126, -v127
    v_pk_fma_f32 v[84:85], v[88:89], v[80:81], v[92:93] neg_lo:[0,0,1] neg_hi:[0,0,1]
    ds_write_b64 v2, v[140:141] offset:11424
    v_pk_fma_f32 v[86:87], v[88:89], v[82:83], v[86:87]
    v_pk_mul_f32 v[136:137], v[126:127], v[114:115]
    v_cvt_pk_bf16_f32 v96, v84, v85
    v_pk_mul_f32 v[130:131], v[126:127], v[112:113]
    v_cvt_pk_bf16_f32 v97, v86, v87
    v_pk_fma_f32 v[128:129], v[124:125], v[112:113], v[136:137] neg_lo:[0,0,1] neg_hi:[0,0,1]
    ds_write_b64 v2, v[96:97] offset:28832
    v_pk_fma_f32 v[130:131], v[124:125], v[114:115], v[130:131]
    v_pk_mul_f32 v[92:93], v[86:87], v[82:83]
    v_cvt_pk_bf16_f32 v138, v128, v129
    v_pk_mul_f32 v[90:91], v[86:87], v[80:81]
    v_cvt_pk_bf16_f32 v139, -v130, -v131
    v_pk_fma_f32 v[88:89], v[84:85], v[80:81], v[92:93] neg_lo:[0,0,1] neg_hi:[0,0,1]
    ds_write_b64 v2, v[138:139] offset:11968
    v_pk_fma_f32 v[90:91], v[84:85], v[82:83], v[90:91]
    v_pk_mul_f32 v[136:137], v[126:127], v[118:119]
    v_cvt_pk_bf16_f32 v94, v88, v89
    v_pk_mul_f32 v[122:123], v[126:127], v[116:117]
    v_cvt_pk_bf16_f32 v95, v90, v91
    v_pk_fma_f32 v[120:121], v[124:125], v[116:117], v[136:137] neg_lo:[0,0,1] neg_hi:[0,0,1]
    ds_write_b64 v2, v[94:95] offset:29376
    v_pk_fma_f32 v[122:123], v[124:125], v[118:119], v[122:123]
    v_pk_mul_f32 v[92:93], v[90:91], v[82:83]
    v_cvt_pk_bf16_f32 v140, v120, v121
    v_pk_mul_f32 v[86:87], v[90:91], v[80:81]
    v_cvt_pk_bf16_f32 v141, -v122, -v123
    v_pk_fma_f32 v[84:85], v[88:89], v[80:81], v[92:93] neg_lo:[0,0,1] neg_hi:[0,0,1]
    ds_write_b64 v2, v[140:141] offset:12512
    v_pk_fma_f32 v[86:87], v[88:89], v[82:83], v[86:87]
    v_pk_mul_f32 v[136:137], v[122:123], v[114:115]
    v_cvt_pk_bf16_f32 v96, v84, v85
    v_pk_mul_f32 v[130:131], v[122:123], v[112:113]
    v_cvt_pk_bf16_f32 v97, v86, v87
    v_pk_fma_f32 v[128:129], v[120:121], v[112:113], v[136:137] neg_lo:[0,0,1] neg_hi:[0,0,1]
    ds_write_b64 v2, v[96:97] offset:29920
    v_pk_fma_f32 v[130:131], v[120:121], v[114:115], v[130:131]
    v_pk_mul_f32 v[92:93], v[86:87], v[82:83]
    v_cvt_pk_bf16_f32 v138, v128, v129
    v_pk_mul_f32 v[90:91], v[86:87], v[80:81]
    v_cvt_pk_bf16_f32 v139, -v130, -v131
    v_pk_fma_f32 v[88:89], v[84:85], v[80:81], v[92:93] neg_lo:[0,0,1] neg_hi:[0,0,1]
    ds_write_b64 v2, v[138:139] offset:13056
    v_pk_fma_f32 v[90:91], v[84:85], v[82:83], v[90:91]
    v_pk_mul_f32 v[136:137], v[122:123], v[118:119]
    v_cvt_pk_bf16_f32 v94, v88, v89
    v_pk_mul_f32 v[126:127], v[122:123], v[116:117]
    v_cvt_pk_bf16_f32 v95, v90, v91
    v_pk_fma_f32 v[124:125], v[120:121], v[116:117], v[136:137] neg_lo:[0,0,1] neg_hi:[0,0,1]
    ds_write_b64 v2, v[94:95] offset:30464
    v_pk_fma_f32 v[126:127], v[120:121], v[118:119], v[126:127]
    v_pk_mul_f32 v[92:93], v[90:91], v[82:83]
    v_cvt_pk_bf16_f32 v140, v124, v125
    v_pk_mul_f32 v[86:87], v[90:91], v[80:81]
    v_cvt_pk_bf16_f32 v141, -v126, -v127
    v_pk_fma_f32 v[84:85], v[88:89], v[80:81], v[92:93] neg_lo:[0,0,1] neg_hi:[0,0,1]
    ds_write_b64 v2, v[140:141] offset:13600
    v_pk_fma_f32 v[86:87], v[88:89], v[82:83], v[86:87]
    v_pk_mul_f32 v[136:137], v[126:127], v[114:115]
    v_cvt_pk_bf16_f32 v96, v84, v85
    v_pk_mul_f32 v[130:131], v[126:127], v[112:113]
    v_cvt_pk_bf16_f32 v97, v86, v87
    v_pk_fma_f32 v[128:129], v[124:125], v[112:113], v[136:137] neg_lo:[0,0,1] neg_hi:[0,0,1]
    ds_write_b64 v2, v[96:97] offset:31008
    v_pk_fma_f32 v[130:131], v[124:125], v[114:115], v[130:131]
    v_pk_mul_f32 v[92:93], v[86:87], v[82:83]
    v_cvt_pk_bf16_f32 v138, v128, v129
    v_pk_mul_f32 v[90:91], v[86:87], v[80:81]
    v_cvt_pk_bf16_f32 v139, -v130, -v131
    v_pk_fma_f32 v[88:89], v[84:85], v[80:81], v[92:93] neg_lo:[0,0,1] neg_hi:[0,0,1]
    ds_write_b64 v2, v[138:139] offset:14144
    v_pk_fma_f32 v[90:91], v[84:85], v[82:83], v[90:91]
    v_cvt_pk_bf16_f32 v94, v88, v89
    v_cvt_pk_bf16_f32 v95, v90, v91
    ds_write_b64 v2, v[94:95] offset:31552
    buffer_load_dwordx4 v[56:59], v52, s[12:15], s52 offen sc1
    v_cndmask_b32 v69, 0, v69, s[58:59]
    s_waitcnt lgkmcnt(0)
    ds_read_b128 v[80:83], v233 offset:14688
    ds_read_b128 v[84:87], v233 offset:23392
    ds_read_b128 v[88:91], v233 offset:14752
    ds_read_b128 v[92:95], v233 offset:23456
    ds_read_b128 v[96:99], v233 offset:14816
    ds_read_b128 v[100:103], v233 offset:23520
    ds_read_b128 v[104:107], v233 offset:14880
    ds_read_b128 v[108:111], v233 offset:23584
    ds_read_b128 v[112:115], v233 offset:14944
    ds_read_b128 v[116:119], v233 offset:23648
    ds_read_b128 v[120:123], v233 offset:15008
    ds_read_b128 v[124:127], v233 offset:23712
    ds_read_b128 v[128:131], v233 offset:15072
    ds_read_b128 v[132:135], v233 offset:23776
    ds_read_b128 v[136:139], v233 offset:15136
    ds_read_b128 v[140:143], v233 offset:23840
    ds_read_b128 v[144:147], v234 offset:0
    ds_read_b128 v[148:151], v234 offset:64
    ds_read_b128 v[152:155], v234 offset:128
    ds_read_b128 v[156:159], v234 offset:192
    ds_read_b128 v[160:163], v234 offset:256
    ds_read_b128 v[164:167], v234 offset:320
    ds_read_b128 v[168:171], v234 offset:384
    ds_read_b128 v[172:175], v234 offset:448
    ds_read_b128 v[176:179], v235 offset:0
    ds_read_b128 v[180:183], v235 offset:64
    ds_read_b128 v[184:187], v235 offset:128
    ds_read_b128 v[188:191], v235 offset:192
    ds_read_b128 v[192:195], v235 offset:256
    ds_read_b128 v[196:199], v235 offset:320
    ds_read_b128 v[200:203], v235 offset:384
    ds_read_b128 v[204:207], v235 offset:448
    s_waitcnt lgkmcnt(8)
    v_mfma_f32_16x16x32_bf16 v[16:19], v[144:147], v[80:83], 0
    v_mfma_f32_16x16x32_bf16 v[20:23], v[144:147], v[84:87], 0
    v_mfma_f32_16x16x32_bf16 v[16:19], v[148:151], v[88:91], v[16:19]
    v_mfma_f32_16x16x32_bf16 v[20:23], v[148:151], v[92:95], v[20:23]
    v_mfma_f32_16x16x32_bf16 v[16:19], v[152:155], v[96:99], v[16:19]
    v_mfma_f32_16x16x32_bf16 v[20:23], v[152:155], v[100:103], v[20:23]
    v_mfma_f32_16x16x32_bf16 v[16:19], v[156:159], v[104:107], v[16:19]
    v_mfma_f32_16x16x32_bf16 v[20:23], v[156:159], v[108:111], v[20:23]
    v_mfma_f32_16x16x32_bf16 v[16:19], v[160:163], v[112:115], v[16:19]
    v_mfma_f32_16x16x32_bf16 v[20:23], v[160:163], v[116:119], v[20:23]
    v_mfma_f32_16x16x32_bf16 v[16:19], v[164:167], v[120:123], v[16:19]
    v_mfma_f32_16x16x32_bf16 v[20:23], v[164:167], v[124:127], v[20:23]
    v_mfma_f32_16x16x32_bf16 v[16:19], v[168:171], v[128:131], v[16:19]
    v_mfma_f32_16x16x32_bf16 v[20:23], v[168:171], v[132:135], v[20:23]
    v_mfma_f32_16x16x32_bf16 v[16:19], v[172:175], v[136:139], v[16:19]
    v_mfma_f32_16x16x32_bf16 v[20:23], v[172:175], v[140:143], v[20:23]
    ds_read_b128 v[144:147], v236 offset:0
    ds_read_b128 v[148:151], v236 offset:64
    ds_read_b128 v[152:155], v236 offset:128
    ds_read_b128 v[156:159], v236 offset:192
    ds_read_b128 v[160:163], v236 offset:256
    ds_read_b128 v[164:167], v236 offset:320
    ds_read_b128 v[168:171], v236 offset:384
    ds_read_b128 v[172:175], v236 offset:448
    s_waitcnt lgkmcnt(8)
    v_mfma_f32_16x16x32_bf16 v[24:27], v[176:179], v[80:83], 0
    v_mfma_f32_16x16x32_bf16 v[28:31], v[176:179], v[84:87], 0
    v_mfma_f32_16x16x32_bf16 v[24:27], v[180:183], v[88:91], v[24:27]
    v_mfma_f32_16x16x32_bf16 v[28:31], v[180:183], v[92:95], v[28:31]
    v_mfma_f32_16x16x32_bf16 v[24:27], v[184:187], v[96:99], v[24:27]
    v_mfma_f32_16x16x32_bf16 v[28:31], v[184:187], v[100:103], v[28:31]
    v_mfma_f32_16x16x32_bf16 v[24:27], v[188:191], v[104:107], v[24:27]
    v_mfma_f32_16x16x32_bf16 v[28:31], v[188:191], v[108:111], v[28:31]
    v_mfma_f32_16x16x32_bf16 v[24:27], v[192:195], v[112:115], v[24:27]
    v_mfma_f32_16x16x32_bf16 v[28:31], v[192:195], v[116:119], v[28:31]
    v_mfma_f32_16x16x32_bf16 v[24:27], v[196:199], v[120:123], v[24:27]
    v_mfma_f32_16x16x32_bf16 v[28:31], v[196:199], v[124:127], v[28:31]
    v_mfma_f32_16x16x32_bf16 v[24:27], v[200:203], v[128:131], v[24:27]
    v_mfma_f32_16x16x32_bf16 v[28:31], v[200:203], v[132:135], v[28:31]
    v_mfma_f32_16x16x32_bf16 v[24:27], v[204:207], v[136:139], v[24:27]
    v_mfma_f32_16x16x32_bf16 v[28:31], v[204:207], v[140:143], v[28:31]
    ds_read_b128 v[176:179], v237 offset:0
    ds_read_b128 v[180:183], v237 offset:64
    ds_read_b128 v[184:187], v237 offset:128
    ds_read_b128 v[188:191], v237 offset:192
    ds_read_b128 v[192:195], v237 offset:256
    ds_read_b128 v[196:199], v237 offset:320
    ds_read_b128 v[200:203], v237 offset:384
    ds_read_b128 v[204:207], v237 offset:448
    s_mov_b32 s41, 0x8000
    s_waitcnt vmcnt(0)
F_cp_p:
    v_xor_b32 v56, s40, v56
    v_xor_b32 v57, s40, v57
    v_xor_b32 v58, s40, v58
    v_xor_b32 v59, s40, v59
    v_or3_b32 v60, v56, v57, v58
    v_or_b32 v60, v60, v59
    v_cmp_ne_u32 vcc, 0, v60
    s_nop 1
    s_cbranch_vccz F_cp_g
    buffer_load_dwordx4 v[56:59], v52, s[12:15], s52 offen sc1
    s_sub_u32 s41, s41, 1
    s_waitcnt vmcnt(0)
    s_cbranch_scc0 F_cp_p
F_cp_g:
    buffer_load_dwordx2 v[224:225], v54, s[12:15], s55 offen sc1
    buffer_load_dwordx2 v[226:227], v54, s[12:15], s56 offen sc1
    buffer_load_dwordx2 v[228:229], v63, s[12:15], s57 offen sc1
    s_add_u32 s25, s53, 0
    buffer_load_dwordx4 v[208:211], v53, s[12:15], s25 offen sc1
    s_add_u32 s25, s53, 147456
    buffer_load_dwordx4 v[212:215], v53, s[12:15], s25 offen sc1
    s_add_u32 s25, s53, 294912
    buffer_load_dwordx4 v[216:219], v53, s[12:15], s25 offen sc1
    s_add_u32 s25, s53, 442368
    buffer_load_dwordx4 v[220:223], v53, s[12:15], s25 offen sc1
    s_waitcnt lgkmcnt(8)
    v_mfma_f32_16x16x32_bf16 v[32:35], v[144:147], v[80:83], 0
    v_mfma_f32_16x16x32_bf16 v[36:39], v[144:147], v[84:87], 0
    v_mfma_f32_16x16x32_bf16 v[32:35], v[148:151], v[88:91], v[32:35]
    v_mfma_f32_16x16x32_bf16 v[36:39], v[148:151], v[92:95], v[36:39]
    v_mfma_f32_16x16x32_bf16 v[32:35], v[152:155], v[96:99], v[32:35]
    v_mfma_f32_16x16x32_bf16 v[36:39], v[152:155], v[100:103], v[36:39]
    v_mfma_f32_16x16x32_bf16 v[32:35], v[156:159], v[104:107], v[32:35]
    v_mfma_f32_16x16x32_bf16 v[36:39], v[156:159], v[108:111], v[36:39]
    v_mfma_f32_16x16x32_bf16 v[32:35], v[160:163], v[112:115], v[32:35]
    v_mfma_f32_16x16x32_bf16 v[36:39], v[160:163], v[116:119], v[36:39]
    v_mfma_f32_16x16x32_bf16 v[32:35], v[164:167], v[120:123], v[32:35]
    v_mfma_f32_16x16x32_bf16 v[36:39], v[164:167], v[124:127], v[36:39]
    v_mfma_f32_16x16x32_bf16 v[32:35], v[168:171], v[128:131], v[32:35]
    v_mfma_f32_16x16x32_bf16 v[36:39], v[168:171], v[132:135], v[36:39]
    v_mfma_f32_16x16x32_bf16 v[32:35], v[172:175], v[136:139], v[32:35]
    v_mfma_f32_16x16x32_bf16 v[36:39], v[172:175], v[140:143], v[36:39]
    s_waitcnt lgkmcnt(0)
    v_mfma_f32_16x16x32_bf16 v[40:43], v[176:179], v[80:83], 0
    ds_write_b32 v232, v63 offset:4096
    ds_write_b16 v231, v63 offset:4094
    v_mfma_f32_16x16x32_bf16 v[44:47], v[176:179], v[84:87], 0
    v_add_f32 v19, v19, v69
    v_cvt_pk_bf16_f32 v16, v16, v17
    v_mfma_f32_16x16x32_bf16 v[40:43], v[180:183], v[88:91], v[40:43]
    v_cvt_pk_bf16_f32 v12, v17, v18
    v_cvt_pk_bf16_f32 v17, v18, v19
    v_mfma_f32_16x16x32_bf16 v[44:47], v[180:183], v[92:95], v[44:47]
    ds_write_b64 v230, v[16:17] offset:3328
    ds_write_b16 v230, v16 offset:7486
    v_mfma_f32_16x16x32_bf16 v[40:43], v[184:187], v[96:99], v[40:43]
    ds_write_b32 v230, v12 offset:7488
    ds_write_b16_d16_hi v230, v17 offset:7492
    v_mfma_f32_16x16x32_bf16 v[44:47], v[184:187], v[100:103], v[44:47]
    v_cvt_pk_bf16_f32 v20, v20, v21
    v_cvt_pk_bf16_f32 v13, v21, v22
    v_mfma_f32_16x16x32_bf16 v[40:43], v[188:191], v[104:107], v[40:43]
    v_cvt_pk_bf16_f32 v21, v22, v23
    ds_write_b64 v230, v[20:21] offset:3072
    v_mfma_f32_16x16x32_bf16 v[44:47], v[188:191], v[108:111], v[44:47]
    ds_write_b16 v230, v20 offset:7230
    ds_write_b32 v230, v13 offset:7232
    v_mfma_f32_16x16x32_bf16 v[40:43], v[192:195], v[112:115], v[40:43]
    ds_write_b16_d16_hi v230, v21 offset:7236
    v_cvt_pk_bf16_f32 v24, v24, v25
    v_mfma_f32_16x16x32_bf16 v[44:47], v[192:195], v[116:119], v[44:47]
    v_cvt_pk_bf16_f32 v12, v25, v26
    v_cvt_pk_bf16_f32 v25, v26, v27
    v_mfma_f32_16x16x32_bf16 v[40:43], v[196:199], v[120:123], v[40:43]
    ds_write_b64 v230, v[24:25] offset:2304
    ds_write_b16 v230, v24 offset:6462
    v_mfma_f32_16x16x32_bf16 v[44:47], v[196:199], v[124:127], v[44:47]
    ds_write_b32 v230, v12 offset:6464
    ds_write_b16_d16_hi v230, v25 offset:6468
    v_mfma_f32_16x16x32_bf16 v[40:43], v[200:203], v[128:131], v[40:43]
    v_cvt_pk_bf16_f32 v28, v28, v29
    v_cvt_pk_bf16_f32 v13, v29, v30
    v_mfma_f32_16x16x32_bf16 v[44:47], v[200:203], v[132:135], v[44:47]
    v_cvt_pk_bf16_f32 v29, v30, v31
    ds_write_b64 v230, v[28:29] offset:2048
    v_mfma_f32_16x16x32_bf16 v[40:43], v[204:207], v[136:139], v[40:43]
    ds_write_b16 v230, v28 offset:6206
    ds_write_b32 v230, v13 offset:6208
    v_mfma_f32_16x16x32_bf16 v[44:47], v[204:207], v[140:143], v[44:47]
    ds_write_b16_d16_hi v230, v29 offset:6212
    v_cndmask_b32 v35, v35, v34, s[60:61]
    v_cvt_pk_bf16_f32 v32, v32, v33
    v_cvt_pk_bf16_f32 v12, v33, v34
    v_cvt_pk_bf16_f32 v33, v34, v35
    ds_write_b64 v230, v[32:33] offset:1280
    ds_write_b16 v230, v32 offset:5438
    ds_write_b32 v230, v12 offset:5440
    ds_write_b16_d16_hi v230, v33 offset:5444
    v_cndmask_b32 v39, v39, v38, s[60:61]
    v_cvt_pk_bf16_f32 v36, v36, v37
    v_cvt_pk_bf16_f32 v13, v37, v38
    v_cvt_pk_bf16_f32 v37, v38, v39
    ds_write_b64 v230, v[36:37] offset:1024
    ds_write_b16 v230, v36 offset:5182
    ds_write_b32 v230, v13 offset:5184
    ds_write_b16_d16_hi v230, v37 offset:5188
    v_cndmask_b32 v43, v43, v42, s[60:61]
    v_cvt_pk_bf16_f32 v40, v40, v41
    v_cvt_pk_bf16_f32 v12, v41, v42
    v_cvt_pk_bf16_f32 v41, v42, v43
    ds_write_b64 v230, v[40:41] offset:256
    ds_write_b16 v230, v40 offset:4414
    ds_write_b32 v230, v12 offset:4416
    ds_write_b16_d16_hi v230, v41 offset:4420
    v_cndmask_b32 v47, v47, v46, s[60:61]
    v_cvt_pk_bf16_f32 v44, v44, v45
    v_cvt_pk_bf16_f32 v13, v45, v46
    v_cvt_pk_bf16_f32 v45, v46, v47
    ds_write_b64 v230, v[44:45] offset:0
    ds_write_b16 v230, v44 offset:4158
    ds_write_b32 v230, v13 offset:4160
    ds_write_b16_d16_hi v230, v45 offset:4164
    v_mov_b32 v32, 0
    v_mov_b32 v33, 0
    v_mov_b32 v34, 0
    v_mov_b32 v35, 0
    ds_write_b128 v246, v[32:35]
    s_mov_b32 s41, 0x8000
    s_waitcnt vmcnt(4)
F_cg_p:
    v_xor_b32 v225, s40, v225
    v_xor_b32 v227, s40, v227
    v_xor_b32 v229, s40, v229
    v_or3_b32 v60, v225, v227, v229
    v_or_b32 v60, v60, v229
    v_cmp_ne_u32 vcc, 0, v60
    s_nop 1
    s_cbranch_vccz F_cg_g
    buffer_load_dwordx2 v[224:225], v54, s[12:15], s55 offen sc1
    buffer_load_dwordx2 v[226:227], v54, s[12:15], s56 offen sc1
    buffer_load_dwordx2 v[228:229], v63, s[12:15], s57 offen sc1
    s_sub_u32 s41, s41, 1
    s_waitcnt vmcnt(0)
    s_cbranch_scc0 F_cg_p
F_cg_g:
    v_add_f32 v9, 1.0, v226
    v_cvt_pk_bf16_f32 v9, v9, v9
    v_and_b32 v9, 0xffff0000, v9
    s_barrier
    s_waitcnt vmcnt(3)
    v_lshlrev_b32 v24, 16, v208
    v_and_b32 v25, 0xffff0000, v208
    v_fma_f32 v24, v24, v9, v224
    v_fma_f32 v25, v25, v9, v224
    v_cvt_pk_bf16_f32 v208, v24, v25
    v_lshlrev_b32 v26, 16, v209
    v_and_b32 v27, 0xffff0000, v209
    v_fma_f32 v26, v26, v9, v224
    v_fma_f32 v27, v27, v9, v224
    v_cvt_pk_bf16_f32 v209, v26, v27
    v_lshlrev_b32 v24, 16, v210
    v_and_b32 v25, 0xffff0000, v210
    v_fma_f32 v24, v24, v9, v224
    v_fma_f32 v25, v25, v9, v224
    v_cvt_pk_bf16_f32 v210, v24, v25
    v_lshlrev_b32 v26, 16, v211
    v_and_b32 v27, 0xffff0000, v211
    v_fma_f32 v26, v26, v9, v224
    v_fma_f32 v27, v27, v9, v224
    v_cvt_pk_bf16_f32 v211, v26, v27
    ds_write_b128 v245, v[208:211] offset:0
    ds_read2_b32 v[64:65], v241 offset0:128 offset1:129
    ds_read2_b32 v[66:67], v241 offset0:130 offset1:131
    ds_read2_b32 v[68:69], v241 offset0:0 offset1:1
    ds_read2_b32 v[70:71], v241 offset0:2 offset1:3
    ds_read2_b32 v[72:73], v240 offset0:128 offset1:129
    ds_read2_b32 v[74:75], v240 offset0:130 offset1:131
    ds_read2_b32 v[76:77], v240 offset0:0 offset1:1
    ds_read2_b32 v[78:79], v240 offset0:2 offset1:3
    s_waitcnt vmcnt(2)
    v_lshlrev_b32 v24, 16, v212
    v_and_b32 v25, 0xffff0000, v212
    v_fma_f32 v24, v24, v9, v224
    v_fma_f32 v25, v25, v9, v224
    v_cvt_pk_bf16_f32 v212, v24, v25
    v_lshlrev_b32 v26, 16, v213
    v_and_b32 v27, 0xffff0000, v213
    v_fma_f32 v26, v26, v9, v224
    v_fma_f32 v27, v27, v9, v224
    v_cvt_pk_bf16_f32 v213, v26, v27
    v_lshlrev_b32 v24, 16, v214
    v_and_b32 v25, 0xffff0000, v214
    v_fma_f32 v24, v24, v9, v224
    v_fma_f32 v25, v25, v9, v224
    v_cvt_pk_bf16_f32 v214, v24, v25
    v_lshlrev_b32 v26, 16, v215
    v_and_b32 v27, 0xffff0000, v215
    v_fma_f32 v26, v26, v9, v224
    v_fma_f32 v27, v27, v9, v224
    v_cvt_pk_bf16_f32 v215, v26, v27
    ds_write_b128 v245, v[212:215] offset:256
    ds_read2_b32 v[80:81], v239 offset0:128 offset1:129
    ds_read2_b32 v[82:83], v239 offset0:130 offset1:131
    ds_read2_b32 v[84:85], v239 offset0:0 offset1:1
    ds_read2_b32 v[86:87], v239 offset0:2 offset1:3
    ds_read2_b32 v[88:89], v238 offset0:128 offset1:129
    ds_read2_b32 v[90:91], v238 offset0:130 offset1:131
    ds_read2_b32 v[92:93], v238 offset0:0 offset1:1
    ds_read2_b32 v[94:95], v238 offset0:2 offset1:3
    s_waitcnt vmcnt(1)
    v_lshlrev_b32 v24, 16, v216
    v_and_b32 v25, 0xffff0000, v216
    v_fma_f32 v24, v24, v9, v224
    v_fma_f32 v25, v25, v9, v224
    v_cvt_pk_bf16_f32 v216, v24, v25
    v_lshlrev_b32 v26, 16, v217
    v_and_b32 v27, 0xffff0000, v217
    v_fma_f32 v26, v26, v9, v224
    v_fma_f32 v27, v27, v9, v224
    v_cvt_pk_bf16_f32 v217, v26, v27
    v_lshlrev_b32 v24, 16, v218
    v_and_b32 v25, 0xffff0000, v218
    v_fma_f32 v24, v24, v9, v224
    v_fma_f32 v25, v25, v9, v224
    v_cvt_pk_bf16_f32 v218, v24, v25
    v_lshlrev_b32 v26, 16, v219
    v_and_b32 v27, 0xffff0000, v219
    v_fma_f32 v26, v26, v9, v224
    v_fma_f32 v27, v27, v9, v224
    v_cvt_pk_bf16_f32 v219, v26, v27
    ds_write_b128 v245, v[216:219] offset:512
    s_waitcnt vmcnt(0)
    v_lshlrev_b32 v24, 16, v220
    v_and_b32 v25, 0xffff0000, v220
    v_fma_f32 v24, v24, v9, v224
    v_fma_f32 v25, v25, v9, v224
    v_cvt_pk_bf16_f32 v220, v24, v25
    v_lshlrev_b32 v26, 16, v221
    v_and_b32 v27, 0xffff0000, v221
    v_fma_f32 v26, v26, v9, v224
    v_fma_f32 v27, v27, v9, v224
    v_cvt_pk_bf16_f32 v221, v26, v27
    v_lshlrev_b32 v24, 16, v222
    v_and_b32 v25, 0xffff0000, v222
    v_fma_f32 v24, v24, v9, v224
    v_fma_f32 v25, v25, v9, v224
    v_cvt_pk_bf16_f32 v222, v24, v25
    v_lshlrev_b32 v26, 16, v223
    v_and_b32 v27, 0xffff0000, v223
    v_fma_f32 v26, v26, v9, v224
    v_fma_f32 v27, v27, v9, v224
    v_cvt_pk_bf16_f32 v223, v26, v27
    ds_write_b128 v245, v[220:223] offset:768
    s_add_u32 m0, s54, 128384
    s_add_u32 s25, s53, 2359296
    buffer_load_dwordx4 v53, s[12:15], s25 offen sc1 lds
    s_add_u32 m0, s54, 129408
    s_add_u32 s25, s53, 2506752
    buffer_load_dwordx4 v53, s[12:15], s25 offen sc1 lds
    s_add_u32 m0, s54, 130432
    s_add_u32 s25, s53, 2654208
    buffer_load_dwordx4 v53, s[12:15], s25 offen sc1 lds
    s_add_u32 m0, s54, 131456
    s_add_u32 s25, s53, 2801664
    buffer_load_dwordx4 v53, s[12:15], s25 offen sc1 lds
    s_waitcnt lgkmcnt(0)
    s_barrier
    ds_read_b128 v[96:99], v242 offset:0
    ds_read_b128 v[100:103], v242 offset:512
    ds_read_b128 v[104:107], v242 offset:1024
    ds_read_b128 v[108:111], v242 offset:1536
    ds_read_b128 v[112:115], v242 offset:2048
    ds_read_b128 v[116:119], v242 offset:2560
    ds_read_b128 v[120:123], v242 offset:3072
    ds_read_b128 v[124:127], v242 offset:3584
    s_cmp_lg_u32 s30, 0
    s_cbranch_scc1 F_nb
    s_mov_b32 s41, 7217152
    s_mov_b64 exec, 1
    buffer_store_dword v62, v63, s[12:15], s41 offen sc1
    s_mov_b64 exec, -1
F_nb:
    v_mov_b32 v32, 0
    v_mov_b32 v33, 0
    v_mov_b32 v34, 0
    v_mov_b32 v35, 0
    v_mov_b32 v36, 0
    v_mov_b32 v37, 0
    v_mov_b32 v38, 0
    v_mov_b32 v39, 0
    v_mov_b32 v40, 0
    v_mov_b32 v41, 0
    v_mov_b32 v42, 0
    v_mov_b32 v43, 0
    v_mov_b32 v44, 0
    v_mov_b32 v45, 0
    v_mov_b32 v46, 0
    v_mov_b32 v47, 0
    v_mov_b32 v48, 0
    v_mov_b32 v49, 0
    v_mov_b32 v50, 0
    v_mov_b32 v51, 0
    v_mov_b32 v52, 0
    v_mov_b32 v53, 0
    v_mov_b32 v54, 0
    v_mov_b32 v55, 0
    v_mov_b32 v56, 0
    v_mov_b32 v57, 0
    v_mov_b32 v58, 0
    v_mov_b32 v59, 0
    v_mov_b32 v60, 0
    v_mov_b32 v61, 0
    v_mov_b32 v62, 0
    v_mov_b32 v63, 0
    v_subrev_u32 v238, 128, v238
    v_subrev_u32 v239, 128, v239
    v_subrev_u32 v240, 128, v240
    v_subrev_u32 v241, 128, v241
    v_subrev_u32 v242, 128, v242
    s_mov_b32 s29, 3
F_loop:
    s_waitcnt lgkmcnt(0)
    v_mfma_f32_16x16x32_bf16 v[32:35], v[64:67], v[96:99], v[32:35]
    ds_read_b128 v[160:163], v242 offset:64
    v_mfma_f32_16x16x32_bf16 v[36:39], v[64:67], v[100:103], v[36:39]
    ds_read2_b32 v[128:129], v241 offset0:144 offset1:145
    v_mfma_f32_16x16x32_bf16 v[36:39], v[68:71], v[96:99], v[36:39]
    ds_read2_b32 v[130:131], v241 offset0:146 offset1:147
    v_mfma_f32_16x16x32_bf16 v[40:43], v[64:67], v[104:107], v[40:43]
    ds_read_b128 v[164:167], v242 offset:576
    v_mfma_f32_16x16x32_bf16 v[40:43], v[68:71], v[100:103], v[40:43]
    ds_read2_b32 v[132:133], v241 offset0:16 offset1:17
    v_mfma_f32_16x16x32_bf16 v[40:43], v[72:75], v[96:99], v[40:43]
    ds_read2_b32 v[134:135], v241 offset0:18 offset1:19
    v_mfma_f32_16x16x32_bf16 v[44:47], v[64:67], v[108:111], v[44:47]
    ds_read_b128 v[168:171], v242 offset:1088
    v_mfma_f32_16x16x32_bf16 v[44:47], v[68:71], v[104:107], v[44:47]
    ds_read2_b32 v[136:137], v240 offset0:144 offset1:145
    v_mfma_f32_16x16x32_bf16 v[44:47], v[72:75], v[100:103], v[44:47]
    ds_read2_b32 v[138:139], v240 offset0:146 offset1:147
    v_mfma_f32_16x16x32_bf16 v[44:47], v[76:79], v[96:99], v[44:47]
    ds_read_b128 v[172:175], v242 offset:1600
    v_mfma_f32_16x16x32_bf16 v[48:51], v[64:67], v[112:115], v[48:51]
    ds_read2_b32 v[140:141], v240 offset0:16 offset1:17
    v_mfma_f32_16x16x32_bf16 v[48:51], v[68:71], v[108:111], v[48:51]
    ds_read2_b32 v[142:143], v240 offset0:18 offset1:19
    v_mfma_f32_16x16x32_bf16 v[48:51], v[72:75], v[104:107], v[48:51]
    ds_read_b128 v[176:179], v242 offset:2112
    v_mfma_f32_16x16x32_bf16 v[48:51], v[76:79], v[100:103], v[48:51]
    ds_read2_b32 v[144:145], v239 offset0:144 offset1:145
    v_mfma_f32_16x16x32_bf16 v[48:51], v[80:83], v[96:99], v[48:51]
    ds_read2_b32 v[146:147], v239 offset0:146 offset1:147
    v_mfma_f32_16x16x32_bf16 v[52:55], v[64:67], v[116:119], v[52:55]
    ds_read_b128 v[180:183], v242 offset:2624
    v_mfma_f32_16x16x32_bf16 v[52:55], v[68:71], v[112:115], v[52:55]
    ds_read2_b32 v[148:149], v239 offset0:16 offset1:17
    v_mfma_f32_16x16x32_bf16 v[52:55], v[72:75], v[108:111], v[52:55]
    ds_read2_b32 v[150:151], v239 offset0:18 offset1:19
    v_mfma_f32_16x16x32_bf16 v[52:55], v[76:79], v[104:107], v[52:55]
    ds_read_b128 v[184:187], v242 offset:3136
    v_mfma_f32_16x16x32_bf16 v[52:55], v[80:83], v[100:103], v[52:55]
    ds_read2_b32 v[152:153], v238 offset0:144 offset1:145
    v_mfma_f32_16x16x32_bf16 v[52:55], v[84:87], v[96:99], v[52:55]
    ds_read2_b32 v[154:155], v238 offset0:146 offset1:147
    v_mfma_f32_16x16x32_bf16 v[56:59], v[64:67], v[120:123], v[56:59]
    ds_read_b128 v[188:191], v242 offset:3648
    v_mfma_f32_16x16x32_bf16 v[56:59], v[68:71], v[116:119], v[56:59]
    ds_read2_b32 v[156:157], v238 offset0:16 offset1:17
    v_mfma_f32_16x16x32_bf16 v[56:59], v[72:75], v[112:115], v[56:59]
    ds_read2_b32 v[158:159], v238 offset0:18 offset1:19
    v_mfma_f32_16x16x32_bf16 v[56:59], v[76:79], v[108:111], v[56:59]
    v_mfma_f32_16x16x32_bf16 v[56:59], v[80:83], v[104:107], v[56:59]
    v_mfma_f32_16x16x32_bf16 v[56:59], v[84:87], v[100:103], v[56:59]
    v_mfma_f32_16x16x32_bf16 v[56:59], v[88:91], v[96:99], v[56:59]
    v_mfma_f32_16x16x32_bf16 v[60:63], v[64:67], v[124:127], v[60:63]
    v_mfma_f32_16x16x32_bf16 v[60:63], v[68:71], v[120:123], v[60:63]
    v_mfma_f32_16x16x32_bf16 v[60:63], v[72:75], v[116:119], v[60:63]
    v_mfma_f32_16x16x32_bf16 v[60:63], v[76:79], v[112:115], v[60:63]
    v_mfma_f32_16x16x32_bf16 v[60:63], v[80:83], v[108:111], v[60:63]
    v_mfma_f32_16x16x32_bf16 v[60:63], v[84:87], v[104:107], v[60:63]
    v_mfma_f32_16x16x32_bf16 v[60:63], v[88:91], v[100:103], v[60:63]
    v_mfma_f32_16x16x32_bf16 v[60:63], v[92:95], v[96:99], v[60:63]
    s_waitcnt lgkmcnt(0)
    v_mfma_f32_16x16x32_bf16 v[32:35], v[128:131], v[160:163], v[32:35]
    ds_read_b128 v[96:99], v242 offset:0
    v_mfma_f32_16x16x32_bf16 v[36:39], v[128:131], v[164:167], v[36:39]
    ds_read2_b32 v[64:65], v241 offset0:128 offset1:129
    v_mfma_f32_16x16x32_bf16 v[36:39], v[132:135], v[160:163], v[36:39]
    ds_read2_b32 v[66:67], v241 offset0:130 offset1:131
    v_mfma_f32_16x16x32_bf16 v[40:43], v[128:131], v[168:171], v[40:43]
    ds_read_b128 v[100:103], v242 offset:512
    v_mfma_f32_16x16x32_bf16 v[40:43], v[132:135], v[164:167], v[40:43]
    ds_read2_b32 v[68:69], v241 offset0:0 offset1:1
    v_mfma_f32_16x16x32_bf16 v[40:43], v[136:139], v[160:163], v[40:43]
    ds_read2_b32 v[70:71], v241 offset0:2 offset1:3
    v_mfma_f32_16x16x32_bf16 v[44:47], v[128:131], v[172:175], v[44:47]
    ds_read_b128 v[104:107], v242 offset:1024
    v_mfma_f32_16x16x32_bf16 v[44:47], v[132:135], v[168:171], v[44:47]
    ds_read2_b32 v[72:73], v240 offset0:128 offset1:129
    v_mfma_f32_16x16x32_bf16 v[44:47], v[136:139], v[164:167], v[44:47]
    ds_read2_b32 v[74:75], v240 offset0:130 offset1:131
    v_mfma_f32_16x16x32_bf16 v[44:47], v[140:143], v[160:163], v[44:47]
    ds_read_b128 v[108:111], v242 offset:1536
    v_mfma_f32_16x16x32_bf16 v[48:51], v[128:131], v[176:179], v[48:51]
    ds_read2_b32 v[76:77], v240 offset0:0 offset1:1
    v_mfma_f32_16x16x32_bf16 v[48:51], v[132:135], v[172:175], v[48:51]
    ds_read2_b32 v[78:79], v240 offset0:2 offset1:3
    v_mfma_f32_16x16x32_bf16 v[48:51], v[136:139], v[168:171], v[48:51]
    ds_read_b128 v[112:115], v242 offset:2048
    v_mfma_f32_16x16x32_bf16 v[48:51], v[140:143], v[164:167], v[48:51]
    ds_read2_b32 v[80:81], v239 offset0:128 offset1:129
    v_mfma_f32_16x16x32_bf16 v[48:51], v[144:147], v[160:163], v[48:51]
    ds_read2_b32 v[82:83], v239 offset0:130 offset1:131
    v_mfma_f32_16x16x32_bf16 v[52:55], v[128:131], v[180:183], v[52:55]
    ds_read_b128 v[116:119], v242 offset:2560
    v_mfma_f32_16x16x32_bf16 v[52:55], v[132:135], v[176:179], v[52:55]
    ds_read2_b32 v[84:85], v239 offset0:0 offset1:1
    v_mfma_f32_16x16x32_bf16 v[52:55], v[136:139], v[172:175], v[52:55]
    ds_read2_b32 v[86:87], v239 offset0:2 offset1:3
    v_mfma_f32_16x16x32_bf16 v[52:55], v[140:143], v[168:171], v[52:55]
    ds_read_b128 v[120:123], v242 offset:3072
    v_mfma_f32_16x16x32_bf16 v[52:55], v[144:147], v[164:167], v[52:55]
    ds_read2_b32 v[88:89], v238 offset0:128 offset1:129
    v_mfma_f32_16x16x32_bf16 v[52:55], v[148:151], v[160:163], v[52:55]
    ds_read2_b32 v[90:91], v238 offset0:130 offset1:131
    v_mfma_f32_16x16x32_bf16 v[56:59], v[128:131], v[184:187], v[56:59]
    ds_read_b128 v[124:127], v242 offset:3584
    v_mfma_f32_16x16x32_bf16 v[56:59], v[132:135], v[180:183], v[56:59]
    ds_read2_b32 v[92:93], v238 offset0:0 offset1:1
    v_mfma_f32_16x16x32_bf16 v[56:59], v[136:139], v[176:179], v[56:59]
    ds_read2_b32 v[94:95], v238 offset0:2 offset1:3
    v_mfma_f32_16x16x32_bf16 v[56:59], v[140:143], v[172:175], v[56:59]
    v_subrev_u32 v238, 128, v238
    v_mfma_f32_16x16x32_bf16 v[56:59], v[144:147], v[168:171], v[56:59]
    v_subrev_u32 v239, 128, v239
    v_mfma_f32_16x16x32_bf16 v[56:59], v[148:151], v[164:167], v[56:59]
    v_subrev_u32 v240, 128, v240
    v_mfma_f32_16x16x32_bf16 v[56:59], v[152:155], v[160:163], v[56:59]
    v_subrev_u32 v241, 128, v241
    v_mfma_f32_16x16x32_bf16 v[60:63], v[128:131], v[188:191], v[60:63]
    v_subrev_u32 v242, 128, v242
    v_mfma_f32_16x16x32_bf16 v[60:63], v[132:135], v[184:187], v[60:63]
    s_sub_u32 s29, s29, 1
    v_mfma_f32_16x16x32_bf16 v[60:63], v[136:139], v[180:183], v[60:63]
    s_cmp_lg_u32 s29, 0
    v_mfma_f32_16x16x32_bf16 v[60:63], v[140:143], v[176:179], v[60:63]
    v_mfma_f32_16x16x32_bf16 v[60:63], v[144:147], v[172:175], v[60:63]
    v_mfma_f32_16x16x32_bf16 v[60:63], v[148:151], v[168:171], v[60:63]
    v_mfma_f32_16x16x32_bf16 v[60:63], v[152:155], v[164:167], v[60:63]
    v_mfma_f32_16x16x32_bf16 v[60:63], v[156:159], v[160:163], v[60:63]
    s_cbranch_scc1 F_loop
    s_waitcnt lgkmcnt(0)
    v_mfma_f32_16x16x32_bf16 v[32:35], v[64:67], v[96:99], v[32:35]
    ds_read_b128 v[160:163], v242 offset:64
    v_mfma_f32_16x16x32_bf16 v[36:39], v[64:67], v[100:103], v[36:39]
    ds_read2_b32 v[128:129], v241 offset0:144 offset1:145
    v_mfma_f32_16x16x32_bf16 v[36:39], v[68:71], v[96:99], v[36:39]
    ds_read2_b32 v[130:131], v241 offset0:146 offset1:147
    v_mfma_f32_16x16x32_bf16 v[40:43], v[64:67], v[104:107], v[40:43]
    ds_read_b128 v[164:167], v242 offset:576
    v_mfma_f32_16x16x32_bf16 v[40:43], v[68:71], v[100:103], v[40:43]
    ds_read2_b32 v[132:133], v241 offset0:16 offset1:17
    v_mfma_f32_16x16x32_bf16 v[40:43], v[72:75], v[96:99], v[40:43]
    ds_read2_b32 v[134:135], v241 offset0:18 offset1:19
    v_mfma_f32_16x16x32_bf16 v[44:47], v[64:67], v[108:111], v[44:47]
    ds_read_b128 v[168:171], v242 offset:1088
    v_mfma_f32_16x16x32_bf16 v[44:47], v[68:71], v[104:107], v[44:47]
    ds_read2_b32 v[136:137], v240 offset0:144 offset1:145
    v_mfma_f32_16x16x32_bf16 v[44:47], v[72:75], v[100:103], v[44:47]
    ds_read2_b32 v[138:139], v240 offset0:146 offset1:147
    v_mfma_f32_16x16x32_bf16 v[44:47], v[76:79], v[96:99], v[44:47]
    ds_read_b128 v[172:175], v242 offset:1600
    v_mfma_f32_16x16x32_bf16 v[48:51], v[64:67], v[112:115], v[48:51]
    ds_read2_b32 v[140:141], v240 offset0:16 offset1:17
    v_mfma_f32_16x16x32_bf16 v[48:51], v[68:71], v[108:111], v[48:51]
    ds_read2_b32 v[142:143], v240 offset0:18 offset1:19
    v_mfma_f32_16x16x32_bf16 v[48:51], v[72:75], v[104:107], v[48:51]
    ds_read_b128 v[176:179], v242 offset:2112
    v_mfma_f32_16x16x32_bf16 v[48:51], v[76:79], v[100:103], v[48:51]
    ds_read2_b32 v[144:145], v239 offset0:144 offset1:145
    v_mfma_f32_16x16x32_bf16 v[48:51], v[80:83], v[96:99], v[48:51]
    ds_read2_b32 v[146:147], v239 offset0:146 offset1:147
    v_mfma_f32_16x16x32_bf16 v[52:55], v[64:67], v[116:119], v[52:55]
    ds_read_b128 v[180:183], v242 offset:2624
    v_mfma_f32_16x16x32_bf16 v[52:55], v[68:71], v[112:115], v[52:55]
    ds_read2_b32 v[148:149], v239 offset0:16 offset1:17
    v_mfma_f32_16x16x32_bf16 v[52:55], v[72:75], v[108:111], v[52:55]
    ds_read2_b32 v[150:151], v239 offset0:18 offset1:19
    v_mfma_f32_16x16x32_bf16 v[52:55], v[76:79], v[104:107], v[52:55]
    ds_read_b128 v[184:187], v242 offset:3136
    v_mfma_f32_16x16x32_bf16 v[52:55], v[80:83], v[100:103], v[52:55]
    ds_read2_b32 v[152:153], v238 offset0:144 offset1:145
    v_mfma_f32_16x16x32_bf16 v[52:55], v[84:87], v[96:99], v[52:55]
    ds_read2_b32 v[154:155], v238 offset0:146 offset1:147
    v_mfma_f32_16x16x32_bf16 v[56:59], v[64:67], v[120:123], v[56:59]
    ds_read_b128 v[188:191], v242 offset:3648
    v_mfma_f32_16x16x32_bf16 v[56:59], v[68:71], v[116:119], v[56:59]
    ds_read2_b32 v[156:157], v238 offset0:16 offset1:17
    v_mfma_f32_16x16x32_bf16 v[56:59], v[72:75], v[112:115], v[56:59]
    ds_read2_b32 v[158:159], v238 offset0:18 offset1:19
    v_mfma_f32_16x16x32_bf16 v[56:59], v[76:79], v[108:111], v[56:59]
    v_mfma_f32_16x16x32_bf16 v[56:59], v[80:83], v[104:107], v[56:59]
    v_mfma_f32_16x16x32_bf16 v[56:59], v[84:87], v[100:103], v[56:59]
    v_mfma_f32_16x16x32_bf16 v[56:59], v[88:91], v[96:99], v[56:59]
    v_mfma_f32_16x16x32_bf16 v[60:63], v[64:67], v[124:127], v[60:63]
    v_mfma_f32_16x16x32_bf16 v[60:63], v[68:71], v[120:123], v[60:63]
    v_mfma_f32_16x16x32_bf16 v[60:63], v[72:75], v[116:119], v[60:63]
    v_mfma_f32_16x16x32_bf16 v[60:63], v[76:79], v[112:115], v[60:63]
    v_mfma_f32_16x16x32_bf16 v[60:63], v[80:83], v[108:111], v[60:63]
    v_mfma_f32_16x16x32_bf16 v[60:63], v[84:87], v[104:107], v[60:63]
    v_mfma_f32_16x16x32_bf16 v[60:63], v[88:91], v[100:103], v[60:63]
    v_mfma_f32_16x16x32_bf16 v[60:63], v[92:95], v[96:99], v[60:63]
    s_waitcnt vmcnt(0) lgkmcnt(0)
    s_barrier
    v_mfma_f32_16x16x32_bf16 v[32:35], v[128:131], v[160:163], v[32:35]
    ds_read_b64 v[16:17], v243 offset:0
    v_mfma_f32_16x16x32_bf16 v[36:39], v[128:131], v[164:167], v[36:39]
    ds_read_b64 v[18:19], v243 offset:2048
    v_mfma_f32_16x16x32_bf16 v[36:39], v[132:135], v[160:163], v[36:39]
    ds_read_b64 v[20:21], v243 offset:4096
    v_mfma_f32_16x16x32_bf16 v[40:43], v[128:131], v[168:171], v[40:43]
    ds_read_b64 v[22:23], v243 offset:6144
    v_mfma_f32_16x16x32_bf16 v[40:43], v[132:135], v[164:167], v[40:43]
    ds_read_b64 v[24:25], v243 offset:8192
    v_mfma_f32_16x16x32_bf16 v[40:43], v[136:139], v[160:163], v[40:43]
    ds_read_b64 v[26:27], v243 offset:10240
    v_mfma_f32_16x16x32_bf16 v[44:47], v[128:131], v[172:175], v[44:47]
    ds_read_b64 v[28:29], v243 offset:12288
    v_mfma_f32_16x16x32_bf16 v[44:47], v[132:135], v[168:171], v[44:47]
    ds_read_b64 v[30:31], v243 offset:14336
    v_mfma_f32_16x16x32_bf16 v[44:47], v[136:139], v[164:167], v[44:47]
    s_lshl_b32 s28, s30, 7
    v_mfma_f32_16x16x32_bf16 v[44:47], v[140:143], v[160:163], v[44:47]
    s_add_u32 s28, s28, 7471104
    v_mfma_f32_16x16x32_bf16 v[48:51], v[128:131], v[176:179], v[48:51]
    v_mfma_f32_16x16x32_bf16 v[48:51], v[132:135], v[172:175], v[48:51]
    v_mfma_f32_16x16x32_bf16 v[48:51], v[136:139], v[168:171], v[48:51]
    v_mfma_f32_16x16x32_bf16 v[48:51], v[140:143], v[164:167], v[48:51]
    v_mfma_f32_16x16x32_bf16 v[48:51], v[144:147], v[160:163], v[48:51]
    v_mfma_f32_16x16x32_bf16 v[52:55], v[128:131], v[180:183], v[52:55]
    v_mfma_f32_16x16x32_bf16 v[52:55], v[132:135], v[176:179], v[52:55]
    v_mfma_f32_16x16x32_bf16 v[52:55], v[136:139], v[172:175], v[52:55]
    v_mfma_f32_16x16x32_bf16 v[52:55], v[140:143], v[168:171], v[52:55]
    v_mfma_f32_16x16x32_bf16 v[52:55], v[144:147], v[164:167], v[52:55]
    v_mfma_f32_16x16x32_bf16 v[52:55], v[148:151], v[160:163], v[52:55]
    v_mfma_f32_16x16x32_bf16 v[56:59], v[128:131], v[184:187], v[56:59]
    v_mfma_f32_16x16x32_bf16 v[56:59], v[132:135], v[180:183], v[56:59]
    v_mfma_f32_16x16x32_bf16 v[56:59], v[136:139], v[176:179], v[56:59]
    v_mfma_f32_16x16x32_bf16 v[56:59], v[140:143], v[172:175], v[56:59]
    v_mfma_f32_16x16x32_bf16 v[56:59], v[144:147], v[168:171], v[56:59]
    v_mfma_f32_16x16x32_bf16 v[56:59], v[148:151], v[164:167], v[56:59]
    v_mfma_f32_16x16x32_bf16 v[56:59], v[152:155], v[160:163], v[56:59]
    v_mfma_f32_16x16x32_bf16 v[60:63], v[128:131], v[188:191], v[60:63]
    v_mfma_f32_16x16x32_bf16 v[60:63], v[132:135], v[184:187], v[60:63]
    v_mfma_f32_16x16x32_bf16 v[60:63], v[136:139], v[180:183], v[60:63]
    v_mfma_f32_16x16x32_bf16 v[60:63], v[140:143], v[176:179], v[60:63]
    v_mfma_f32_16x16x32_bf16 v[60:63], v[144:147], v[172:175], v[60:63]
    v_mfma_f32_16x16x32_bf16 v[60:63], v[148:151], v[168:171], v[60:63]
    v_mfma_f32_16x16x32_bf16 v[60:63], v[152:155], v[164:167], v[60:63]
    v_mfma_f32_16x16x32_bf16 v[60:63], v[156:159], v[160:163], v[60:63]
    s_waitcnt lgkmcnt(0)
    v_lshlrev_b32 v64, 16, v16
    v_and_b32 v65, 0xffff0000, v16
    v_lshlrev_b32 v66, 16, v17
    v_and_b32 v67, 0xffff0000, v17
    v_fmac_f32 v64, v228, v32
    v_fmac_f32 v65, v228, v33
    v_fmac_f32 v66, v228, v34
    v_fmac_f32 v67, v228, v35
    v_cvt_pk_bf16_f32 v16, v64, v65
    v_cvt_pk_bf16_f32 v17, v66, v67
    v_lshlrev_b32 v68, 16, v18
    v_and_b32 v69, 0xffff0000, v18
    v_lshlrev_b32 v70, 16, v19
    v_and_b32 v71, 0xffff0000, v19
    v_fmac_f32 v68, v228, v36
    v_fmac_f32 v69, v228, v37
    v_fmac_f32 v70, v228, v38
    v_fmac_f32 v71, v228, v39
    v_cvt_pk_bf16_f32 v18, v68, v69
    v_cvt_pk_bf16_f32 v19, v70, v71
    s_nop 1
    v_permlane16_swap_b32 v16, v18
    v_permlane16_swap_b32 v17, v19
    s_nop 1
    buffer_store_dwordx4 v[16:19], v244, s[12:15], s28 offen sc1
    s_add_u32 s28, s28, 589824
    v_lshlrev_b32 v64, 16, v20
    v_and_b32 v65, 0xffff0000, v20
    v_lshlrev_b32 v66, 16, v21
    v_and_b32 v67, 0xffff0000, v21
    v_fmac_f32 v64, v228, v40
    v_fmac_f32 v65, v228, v41
    v_fmac_f32 v66, v228, v42
    v_fmac_f32 v67, v228, v43
    v_cvt_pk_bf16_f32 v20, v64, v65
    v_cvt_pk_bf16_f32 v21, v66, v67
    v_lshlrev_b32 v68, 16, v22
    v_and_b32 v69, 0xffff0000, v22
    v_lshlrev_b32 v70, 16, v23
    v_and_b32 v71, 0xffff0000, v23
    v_fmac_f32 v68, v228, v44
    v_fmac_f32 v69, v228, v45
    v_fmac_f32 v70, v228, v46
    v_fmac_f32 v71, v228, v47
    v_cvt_pk_bf16_f32 v22, v68, v69
    v_cvt_pk_bf16_f32 v23, v70, v71
    s_nop 1
    v_permlane16_swap_b32 v20, v22
    v_permlane16_swap_b32 v21, v23
    s_nop 1
    buffer_store_dwordx4 v[20:23], v244, s[12:15], s28 offen sc1
    s_add_u32 s28, s28, 589824
    v_lshlrev_b32 v64, 16, v24
    v_and_b32 v65, 0xffff0000, v24
    v_lshlrev_b32 v66, 16, v25
    v_and_b32 v67, 0xffff0000, v25
    v_fmac_f32 v64, v228, v48
    v_fmac_f32 v65, v228, v49
    v_fmac_f32 v66, v228, v50
    v_fmac_f32 v67, v228, v51
    v_cvt_pk_bf16_f32 v24, v64, v65
    v_cvt_pk_bf16_f32 v25, v66, v67
    v_lshlrev_b32 v68, 16, v26
    v_and_b32 v69, 0xffff0000, v26
    v_lshlrev_b32 v70, 16, v27
    v_and_b32 v71, 0xffff0000, v27
    v_fmac_f32 v68, v228, v52
    v_fmac_f32 v69, v228, v53
    v_fmac_f32 v70, v228, v54
    v_fmac_f32 v71, v228, v55
    v_cvt_pk_bf16_f32 v26, v68, v69
    v_cvt_pk_bf16_f32 v27, v70, v71
    s_nop 1
    v_permlane16_swap_b32 v24, v26
    v_permlane16_swap_b32 v25, v27
    s_nop 1
    buffer_store_dwordx4 v[24:27], v244, s[12:15], s28 offen sc1
    s_add_u32 s28, s28, 589824
    v_lshlrev_b32 v64, 16, v28
    v_and_b32 v65, 0xffff0000, v28
    v_lshlrev_b32 v66, 16, v29
    v_and_b32 v67, 0xffff0000, v29
    v_fmac_f32 v64, v228, v56
    v_fmac_f32 v65, v228, v57
    v_fmac_f32 v66, v228, v58
    v_fmac_f32 v67, v228, v59
    v_cvt_pk_bf16_f32 v28, v64, v65
    v_cvt_pk_bf16_f32 v29, v66, v67
    v_lshlrev_b32 v68, 16, v30
    v_and_b32 v69, 0xffff0000, v30
    v_lshlrev_b32 v70, 16, v31
    v_and_b32 v71, 0xffff0000, v31
    v_fmac_f32 v68, v228, v60
    v_fmac_f32 v69, v228, v61
    v_fmac_f32 v70, v228, v62
    v_fmac_f32 v71, v228, v63
    v_cvt_pk_bf16_f32 v30, v68, v69
    v_cvt_pk_bf16_f32 v31, v70, v71
    s_nop 1
    v_permlane16_swap_b32 v28, v30
    v_permlane16_swap_b32 v29, v31
    s_nop 1
    buffer_store_dwordx4 v[28:31], v244, s[12:15], s28 offen sc1
    s_add_u32 s28, s28, 589824
    s_endpgm
F_hp:
    s_mov_b32 s63, 1
    s_cmp_ge_u32 s3, 108
    s_cbranch_scc1 F_sp
    v_lshrrev_b32 v64, 2, v0
    v_lshlrev_b32 v64, 1, v64
    global_load_ushort v68, v64, s[48:49] offset:0
    global_load_ushort v69, v64, s[48:49] offset:128
    global_load_ushort v70, v64, s[48:49] offset:256
    global_load_ushort v71, v64, s[48:49] offset:384
    global_load_ushort v72, v64, s[48:49] offset:512
    global_load_ushort v73, v64, s[48:49] offset:640
    global_load_ushort v74, v64, s[48:49] offset:768
    global_load_ushort v75, v64, s[48:49] offset:896
    global_load_ushort v76, v64, s[48:49] offset:1024
    s_mov_b32 s8, s50
    s_mov_b32 s9, s51
    s_mov_b32 s10, 0x3cc000
    s_mov_b32 s11, 0x20000
    s_lshl_b32 s18, s3, 6
    v_mul_u32_u24 v66, 3456, v64
    v_lshl_add_u32 v66, v65, 4, v66
    buffer_load_dwordx4 v[80:83], v66, s[8:11], s18 offen
    s_add_u32 s18, s18, 442368
    buffer_load_dwordx4 v[84:87], v66, s[8:11], s18 offen
    s_add_u32 s18, s18, 442368
    buffer_load_dwordx4 v[88:91], v66, s[8:11], s18 offen
    s_add_u32 s18, s18, 442368
    buffer_load_dwordx4 v[92:95], v66, s[8:11], s18 offen
    s_add_u32 s18, s18, 442368
    buffer_load_dwordx4 v[96:99], v66, s[8:11], s18 offen
    s_add_u32 s18, s18, 442368
    buffer_load_dwordx4 v[100:103], v66, s[8:11], s18 offen
    s_add_u32 s18, s18, 442368
    buffer_load_dwordx4 v[104:107], v66, s[8:11], s18 offen
    s_add_u32 s18, s18, 442368
    buffer_load_dwordx4 v[108:111], v66, s[8:11], s18 offen
    s_add_u32 s18, s18, 442368
    buffer_load_dwordx4 v[112:115], v66, s[8:11], s18 offen
    s_waitcnt vmcnt(18)
    s_branch F_ln
F_hp2:
    s_cmp_ge_u32 s3, 108
    s_cbranch_scc1 F_h3
    s_waitcnt vmcnt(15)
    v_lshlrev_b32 v68, 16, v68
    v_lshlrev_b32 v69, 16, v69
    v_lshlrev_b32 v70, 16, v70
    v_lshlrev_b32 v71, 16, v71
    v_lshlrev_b32 v72, 16, v72
    v_lshlrev_b32 v73, 16, v73
    v_lshlrev_b32 v74, 16, v74
    v_lshlrev_b32 v75, 16, v75
    v_lshlrev_b32 v76, 16, v76
    v_mul_f32 v44, 0xbfb8aa3b, v68
    v_mul_f32 v45, 0xbfb8aa3b, v69
    v_mul_f32 v46, 0xbfb8aa3b, v70
    v_mul_f32 v47, 0xbfb8aa3b, v71
    v_mul_f32 v48, 0xbfb8aa3b, v72
    v_mul_f32 v49, 0xbfb8aa3b, v73
    v_mul_f32 v50, 0xbfb8aa3b, v74
    v_mul_f32 v51, 0xbfb8aa3b, v75
    v_mul_f32 v52, 0xbfb8aa3b, v76
    v_exp_f32 v44, v44
    v_exp_f32 v45, v45
    v_exp_f32 v46, v46
    v_exp_f32 v47, v47
    v_exp_f32 v48, v48
    v_exp_f32 v49, v49
    v_exp_f32 v50, v50
    v_exp_f32 v51, v51
    v_exp_f32 v52, v52
    v_add_f32 v44, 1.0, v44
    v_add_f32 v45, 1.0, v45
    v_add_f32 v46, 1.0, v46
    v_add_f32 v47, 1.0, v47
    v_add_f32 v48, 1.0, v48
    v_add_f32 v49, 1.0, v49
    v_add_f32 v50, 1.0, v50
    v_add_f32 v51, 1.0, v51
    v_add_f32 v52, 1.0, v52
    v_rcp_f32 v44, v44
    v_rcp_f32 v45, v45
    v_rcp_f32 v46, v46
    v_rcp_f32 v47, v47
    v_rcp_f32 v48, v48
    v_rcp_f32 v49, v49
    v_rcp_f32 v50, v50
    v_rcp_f32 v51, v51
    v_rcp_f32 v52, v52
    v_mul_f32 v68, v68, v44
    v_mul_f32 v69, v69, v45
    v_mul_f32 v70, v70, v46
    v_mul_f32 v71, v71, v47
    v_mul_f32 v72, v72, v48
    v_mul_f32 v73, v73, v49
    v_mul_f32 v74, v74, v50
    v_mul_f32 v75, v75, v51
    v_mul_f32 v76, v76, v52
    v_cvt_pk_bf16_f32 v68, v68, v68
    v_and_b32 v68, 0xffff0000, v68
    v_cvt_pk_bf16_f32 v69, v69, v69
    v_and_b32 v69, 0xffff0000, v69
    v_cvt_pk_bf16_f32 v70, v70, v70
    v_and_b32 v70, 0xffff0000, v70
    v_cvt_pk_bf16_f32 v71, v71, v71
    v_and_b32 v71, 0xffff0000, v71
    v_cvt_pk_bf16_f32 v72, v72, v72
    v_and_b32 v72, 0xffff0000, v72
    v_cvt_pk_bf16_f32 v73, v73, v73
    v_and_b32 v73, 0xffff0000, v73
    v_cvt_pk_bf16_f32 v74, v74, v74
    v_and_b32 v74, 0xffff0000, v74
    v_cvt_pk_bf16_f32 v75, v75, v75
    v_and_b32 v75, 0xffff0000, v75
    v_cvt_pk_bf16_f32 v76, v76, v76
    v_and_b32 v76, 0xffff0000, v76
    s_waitcnt vmcnt(14)
    v_lshlrev_b32 v60, 16, v80
    v_and_b32 v61, 0xffff0000, v80
    v_mul_f32 v52, v60, v68
    v_mul_f32 v53, v61, v68
    v_lshlrev_b32 v60, 16, v81
    v_and_b32 v61, 0xffff0000, v81
    v_mul_f32 v54, v60, v68
    v_mul_f32 v55, v61, v68
    v_lshlrev_b32 v60, 16, v82
    v_and_b32 v61, 0xffff0000, v82
    v_mul_f32 v56, v60, v68
    v_mul_f32 v57, v61, v68
    v_lshlrev_b32 v60, 16, v83
    v_and_b32 v61, 0xffff0000, v83
    v_mul_f32 v58, v60, v68
    v_mul_f32 v59, v61, v68
    s_waitcnt vmcnt(13)
    v_lshlrev_b32 v60, 16, v84
    v_and_b32 v61, 0xffff0000, v84
    v_fmac_f32 v52, v60, v69
    v_fmac_f32 v53, v61, v69
    v_lshlrev_b32 v60, 16, v85
    v_and_b32 v61, 0xffff0000, v85
    v_fmac_f32 v54, v60, v69
    v_fmac_f32 v55, v61, v69
    v_lshlrev_b32 v60, 16, v86
    v_and_b32 v61, 0xffff0000, v86
    v_fmac_f32 v56, v60, v69
    v_fmac_f32 v57, v61, v69
    v_lshlrev_b32 v60, 16, v87
    v_and_b32 v61, 0xffff0000, v87
    v_fmac_f32 v58, v60, v69
    v_fmac_f32 v59, v61, v69
    s_waitcnt vmcnt(12)
    v_lshlrev_b32 v60, 16, v88
    v_and_b32 v61, 0xffff0000, v88
    v_fmac_f32 v52, v60, v70
    v_fmac_f32 v53, v61, v70
    v_lshlrev_b32 v60, 16, v89
    v_and_b32 v61, 0xffff0000, v89
    v_fmac_f32 v54, v60, v70
    v_fmac_f32 v55, v61, v70
    v_lshlrev_b32 v60, 16, v90
    v_and_b32 v61, 0xffff0000, v90
    v_fmac_f32 v56, v60, v70
    v_fmac_f32 v57, v61, v70
    v_lshlrev_b32 v60, 16, v91
    v_and_b32 v61, 0xffff0000, v91
    v_fmac_f32 v58, v60, v70
    v_fmac_f32 v59, v61, v70
    s_waitcnt vmcnt(11)
    v_lshlrev_b32 v60, 16, v92
    v_and_b32 v61, 0xffff0000, v92
    v_fmac_f32 v52, v60, v71
    v_fmac_f32 v53, v61, v71
    v_lshlrev_b32 v60, 16, v93
    v_and_b32 v61, 0xffff0000, v93
    v_fmac_f32 v54, v60, v71
    v_fmac_f32 v55, v61, v71
    v_lshlrev_b32 v60, 16, v94
    v_and_b32 v61, 0xffff0000, v94
    v_fmac_f32 v56, v60, v71
    v_fmac_f32 v57, v61, v71
    v_lshlrev_b32 v60, 16, v95
    v_and_b32 v61, 0xffff0000, v95
    v_fmac_f32 v58, v60, v71
    v_fmac_f32 v59, v61, v71
    s_waitcnt vmcnt(0)
    s_mov_b64 exec, 1
    buffer_store_dword v62, v63, s[12:15], s42 offen sc1
    s_mov_b64 exec, -1
    v_lshlrev_b32 v60, 16, v96
    v_and_b32 v61, 0xffff0000, v96
    v_fmac_f32 v52, v60, v72
    v_fmac_f32 v53, v61, v72
    v_lshlrev_b32 v60, 16, v97
    v_and_b32 v61, 0xffff0000, v97
    v_fmac_f32 v54, v60, v72
    v_fmac_f32 v55, v61, v72
    v_lshlrev_b32 v60, 16, v98
    v_and_b32 v61, 0xffff0000, v98
    v_fmac_f32 v56, v60, v72
    v_fmac_f32 v57, v61, v72
    v_lshlrev_b32 v60, 16, v99
    v_and_b32 v61, 0xffff0000, v99
    v_fmac_f32 v58, v60, v72
    v_fmac_f32 v59, v61, v72
    v_lshlrev_b32 v60, 16, v100
    v_and_b32 v61, 0xffff0000, v100
    v_fmac_f32 v52, v60, v73
    v_fmac_f32 v53, v61, v73
    v_lshlrev_b32 v60, 16, v101
    v_and_b32 v61, 0xffff0000, v101
    v_fmac_f32 v54, v60, v73
    v_fmac_f32 v55, v61, v73
    v_lshlrev_b32 v60, 16, v102
    v_and_b32 v61, 0xffff0000, v102
    v_fmac_f32 v56, v60, v73
    v_fmac_f32 v57, v61, v73
    v_lshlrev_b32 v60, 16, v103
    v_and_b32 v61, 0xffff0000, v103
    v_fmac_f32 v58, v60, v73
    v_fmac_f32 v59, v61, v73
    v_lshlrev_b32 v60, 16, v104
    v_and_b32 v61, 0xffff0000, v104
    v_fmac_f32 v52, v60, v74
    v_fmac_f32 v53, v61, v74
    v_lshlrev_b32 v60, 16, v105
    v_and_b32 v61, 0xffff0000, v105
    v_fmac_f32 v54, v60, v74
    v_fmac_f32 v55, v61, v74
    v_lshlrev_b32 v60, 16, v106
    v_and_b32 v61, 0xffff0000, v106
    v_fmac_f32 v56, v60, v74
    v_fmac_f32 v57, v61, v74
    v_lshlrev_b32 v60, 16, v107
    v_and_b32 v61, 0xffff0000, v107
    v_fmac_f32 v58, v60, v74
    v_fmac_f32 v59, v61, v74
    v_lshlrev_b32 v60, 16, v108
    v_and_b32 v61, 0xffff0000, v108
    v_fmac_f32 v52, v60, v75
    v_fmac_f32 v53, v61, v75
    v_lshlrev_b32 v60, 16, v109
    v_and_b32 v61, 0xffff0000, v109
    v_fmac_f32 v54, v60, v75
    v_fmac_f32 v55, v61, v75
    v_lshlrev_b32 v60, 16, v110
    v_and_b32 v61, 0xffff0000, v110
    v_fmac_f32 v56, v60, v75
    v_fmac_f32 v57, v61, v75
    v_lshlrev_b32 v60, 16, v111
    v_and_b32 v61, 0xffff0000, v111
    v_fmac_f32 v58, v60, v75
    v_fmac_f32 v59, v61, v75
    v_lshlrev_b32 v60, 16, v112
    v_and_b32 v61, 0xffff0000, v112
    v_fmac_f32 v52, v60, v76
    v_fmac_f32 v53, v61, v76
    v_lshlrev_b32 v60, 16, v113
    v_and_b32 v61, 0xffff0000, v113
    v_fmac_f32 v54, v60, v76
    v_fmac_f32 v55, v61, v76
    v_lshlrev_b32 v60, 16, v114
    v_and_b32 v61, 0xffff0000, v114
    v_fmac_f32 v56, v60, v76
    v_fmac_f32 v57, v61, v76
    v_lshlrev_b32 v60, 16, v115
    v_and_b32 v61, 0xffff0000, v115
    v_fmac_f32 v58, v60, v76
    v_fmac_f32 v59, v61, v76
    v_lshrrev_b32 v1, 4, v0
    v_lshlrev_b32 v1, 7, v1
    v_lshl_add_u32 v1, v65, 5, v1
    v_add_u32 v1, 100352, v1
    v_add_f32_dpp v52, v52, v52 row_ror:4 row_mask:0xf bank_mask:0xf
    v_add_f32_dpp v53, v53, v53 row_ror:4 row_mask:0xf bank_mask:0xf
    v_add_f32_dpp v54, v54, v54 row_ror:4 row_mask:0xf bank_mask:0xf
    v_add_f32_dpp v55, v55, v55 row_ror:4 row_mask:0xf bank_mask:0xf
    v_add_f32_dpp v56, v56, v56 row_ror:4 row_mask:0xf bank_mask:0xf
    v_add_f32_dpp v57, v57, v57 row_ror:4 row_mask:0xf bank_mask:0xf
    v_add_f32_dpp v58, v58, v58 row_ror:4 row_mask:0xf bank_mask:0xf
    v_add_f32_dpp v59, v59, v59 row_ror:4 row_mask:0xf bank_mask:0xf
    v_add_f32_dpp v52, v52, v52 row_ror:8 row_mask:0xf bank_mask:0xf
    v_add_f32_dpp v53, v53, v53 row_ror:8 row_mask:0xf bank_mask:0xf
    v_add_f32_dpp v54, v54, v54 row_ror:8 row_mask:0xf bank_mask:0xf
    v_add_f32_dpp v55, v55, v55 row_ror:8 row_mask:0xf bank_mask:0xf
    v_add_f32_dpp v56, v56, v56 row_ror:8 row_mask:0xf bank_mask:0xf
    v_add_f32_dpp v57, v57, v57 row_ror:8 row_mask:0xf bank_mask:0xf
    v_add_f32_dpp v58, v58, v58 row_ror:8 row_mask:0xf bank_mask:0xf
    v_add_f32_dpp v59, v59, v59 row_ror:8 row_mask:0xf bank_mask:0xf
    ds_write_b128 v1, v[52:55]
    ds_write_b128 v1, v[56:59] offset:16
    s_waitcnt lgkmcnt(0)
    s_barrier
    s_cmp_lg_u32 s16, 0
    s_cbranch_scc1 F_h1
    v_and_b32 v1, 31, v0
    v_lshlrev_b32 v1, 2, v1
    v_add_u32 v2, 100352, v1
    v_add_u32 v3, 101376, v1
    ds_read2_b32 v[44:45], v2 offset0:0 offset1:32
    ds_read2_b32 v[46:47], v2 offset0:64 offset1:96
    ds_read2_b32 v[48:49], v2 offset0:128 offset1:160
    ds_read2_b32 v[50:51], v2 offset0:192 offset1:224
    ds_read2_b32 v[52:53], v3 offset0:0 offset1:32
    ds_read2_b32 v[54:55], v3 offset0:64 offset1:96
    ds_read2_b32 v[56:57], v3 offset0:128 offset1:160
    ds_read2_b32 v[58:59], v3 offset0:192 offset1:224
    s_waitcnt lgkmcnt(0)
    v_add_f32 v44, v44, v52
    v_add_f32 v45, v45, v53
    v_add_f32 v46, v46, v54
    v_add_f32 v47, v47, v55
    v_add_f32 v48, v48, v56
    v_add_f32 v49, v49, v57
    v_add_f32 v50, v50, v58
    v_add_f32 v51, v51, v59
    v_add_f32 v44, v44, v48
    v_add_f32 v45, v45, v49
    v_add_f32 v46, v46, v50
    v_add_f32 v47, v47, v51
    v_add_f32 v44, v44, v46
    v_add_f32 v45, v45, v47
    v_add_f32 v44, v44, v45
    v_cvt_pk_bf16_f32 v44, v44, v44
    v_and_b32 v44, 0xffff0000, v44
    s_lshl_b32 s18, s3, 7
    s_add_u32 s18, s18, 7143424
    s_lshl_b32 s19, s3, 8
    s_add_u32 s19, s19, 7176192
    v_mov_b32 v45, s40
    v_lshlrev_b32 v2, 1, v1
    s_mov_b32 exec_hi, 0
    buffer_store_dwordx2 v[44:45], v2, s[12:15], s19 offen sc1
    buffer_store_dword v44, v1, s[12:15], s18 offen sc1
    s_mov_b64 exec, -1
    s_lshl_b32 s42, s3, 4
    s_add_u32 s42, s42, 7213056
F_h3:
    s_waitcnt vmcnt(0)
    s_mov_b64 exec, 1
    buffer_store_dword v62, v63, s[12:15], s42 offen sc1
    s_mov_b64 exec, -1
F_h1:
    v_mov_b32 v0, v78
    s_barrier
    s_and_b32 s17, s2, 7
    s_lshl_b32 s18, s43, 2
    s_add_u32 s18, s18, s16
    s_cmp_ge_u32 s18, 54
    s_cbranch_scc1 F_exit2
    s_mul_i32 s20, s18, 57
    s_lshr_b32 s20, s20, 9
    s_mul_i32 s19, s20, 9
    s_sub_u32 s19, s18, s19
    s_mul_i32 s21, s20, 110592
    s_mul_i32 s22, s17, 663552
    s_add_u32 s21, s21, s22
    s_lshl_b32 s22, s19, 7
    s_add_u32 s21, s21, s22
    v_lshrrev_b32 v2, 3, v0
    v_and_b32 v3, 6, v2
    v_and_b32 v4, 7, v0
    v_xor_b32 v3, v3, v4
    v_lshlrev_b32 v3, 4, v3
    v_mul_u32_u24 v2, 1152, v2
    v_add_u32 v2, v2, v3
    s_mul_i32 s23, s16, 24576
    s_add_u32 s23, s23, 0
    s_mov_b32 s8, s46
    s_mov_b32 s9, s47
    s_mov_b32 s10, 0x510000
    s_mov_b32 s11, 0x20000
    s_add_u32 m0, s23, 0
    s_nop 0
    buffer_load_dwordx4 v2, s[8:11], s21 offen lds
    s_add_u32 s21, s21, 9216
    s_add_u32 m0, s23, 1024
    s_nop 0
    buffer_load_dwordx4 v2, s[8:11], s21 offen lds
    s_add_u32 s21, s21, 9216
    s_add_u32 m0, s23, 2048
    s_nop 0
    buffer_load_dwordx4 v2, s[8:11], s21 offen lds
    s_add_u32 s21, s21, 9216
    s_add_u32 m0, s23, 3072
    s_nop 0
    buffer_load_dwordx4 v2, s[8:11], s21 offen lds
    s_add_u32 s21, s21, 9216
    s_add_u32 m0, s23, 4096
    s_nop 0
    buffer_load_dwordx4 v2, s[8:11], s21 offen lds
    s_add_u32 s21, s21, 9216
    s_add_u32 m0, s23, 5120
    s_nop 0
    buffer_load_dwordx4 v2, s[8:11], s21 offen lds
    s_add_u32 s21, s21, 9216
    s_add_u32 m0, s23, 6144
    s_nop 0
    buffer_load_dwordx4 v2, s[8:11], s21 offen lds
    s_add_u32 s21, s21, 9216
    s_add_u32 m0, s23, 7168
    s_nop 0
    buffer_load_dwordx4 v2, s[8:11], s21 offen lds
    s_add_u32 s21, s21, 9216
    s_add_u32 m0, s23, 8192
    s_nop 0
    buffer_load_dwordx4 v2, s[8:11], s21 offen lds
    s_add_u32 s21, s21, 9216
    s_add_u32 m0, s23, 9216
    s_nop 0
    buffer_load_dwordx4 v2, s[8:11], s21 offen lds
    s_add_u32 s21, s21, 9216
    s_add_u32 m0, s23, 10240
    s_nop 0
    buffer_load_dwordx4 v2, s[8:11], s21 offen lds
    s_add_u32 s21, s21, 9216
    s_add_u32 m0, s23, 11264
    s_nop 0
    buffer_load_dwordx4 v2, s[8:11], s21 offen lds
    v_and_b32 v60, 3, v0
    v_min_u32 v60, 2, v60
    v_bfe_u32 v6, v0, 2, 1
    v_mul_u32_u24 v6, 18, v6
    v_add_u32 v60, v60, v6
    v_lshlrev_b32 v60, 4, v60
    s_mul_i32 s29, s20, 48
    s_add_u32 s29, s29, 7213920
    buffer_load_dword v61, v60, s[12:15], s29 offen sc1
    s_mul_i32 s21, s20, 884736
    s_mul_i32 s22, s17, 1152
    s_add_u32 s21, s21, s22
    s_lshl_b32 s22, s19, 7
    s_add_u32 s21, s21, s22
    v_lshrrev_b32 v2, 3, v0
    v_and_b32 v3, 6, v2
    v_and_b32 v4, 7, v0
    v_xor_b32 v3, v3, v4
    v_lshlrev_b32 v3, 4, v3
    v_mul_u32_u24 v2, 9216, v2
    v_add_u32 v2, v2, v3
    s_mul_i32 s23, s16, 24576
    s_add_u32 s23, s23, 12288
    s_mov_b32 s8, s44
    s_mov_b32 s9, s45
    s_mov_b32 s10, 0x510000
    s_mov_b32 s11, 0x20000
    s_add_u32 m0, s23, 0
    s_nop 0
    buffer_load_dwordx4 v2, s[8:11], s21 offen lds
    s_add_u32 s21, s21, 73728
    s_add_u32 m0, s23, 1024
    s_nop 0
    buffer_load_dwordx4 v2, s[8:11], s21 offen lds
    s_add_u32 s21, s21, 73728
    s_add_u32 m0, s23, 2048
    s_nop 0
    buffer_load_dwordx4 v2, s[8:11], s21 offen lds
    s_add_u32 s21, s21, 73728
    s_add_u32 m0, s23, 3072
    s_nop 0
    buffer_load_dwordx4 v2, s[8:11], s21 offen lds
    s_add_u32 s21, s21, 73728
    s_add_u32 m0, s23, 4096
    s_nop 0
    buffer_load_dwordx4 v2, s[8:11], s21 offen lds
    s_add_u32 s21, s21, 73728
    s_add_u32 m0, s23, 5120
    s_nop 0
    buffer_load_dwordx4 v2, s[8:11], s21 offen lds
    s_add_u32 s21, s21, 73728
    s_add_u32 m0, s23, 6144
    s_nop 0
    buffer_load_dwordx4 v2, s[8:11], s21 offen lds
    s_add_u32 s21, s21, 73728
    s_add_u32 m0, s23, 7168
    s_nop 0
    buffer_load_dwordx4 v2, s[8:11], s21 offen lds
    s_add_u32 s21, s21, 73728
    s_add_u32 m0, s23, 8192
    s_nop 0
    buffer_load_dwordx4 v2, s[8:11], s21 offen lds
    s_add_u32 s21, s21, 73728
    s_add_u32 m0, s23, 9216
    s_nop 0
    buffer_load_dwordx4 v2, s[8:11], s21 offen lds
    s_add_u32 s21, s21, 73728
    s_add_u32 m0, s23, 10240
    s_nop 0
    buffer_load_dwordx4 v2, s[8:11], s21 offen lds
    s_add_u32 s21, s21, 73728
    s_add_u32 m0, s23, 11264
    s_nop 0
    buffer_load_dwordx4 v2, s[8:11], s21 offen lds
    s_mov_b32 s25, 0x8000
    s_waitcnt vmcnt(12)
F_mp:
    v_cmp_ne_u32 vcc, s40, v61
    s_nop 1
    s_cbranch_vccz F_mg
    buffer_load_dword v61, v60, s[12:15], s29 offen sc1
    s_sub_u32 s25, s25, 1
    s_waitcnt vmcnt(0)
    s_cbranch_scc0 F_mp
F_mg:
    v_lshrrev_b32 v5, 4, v0
    v_lshlrev_b32 v5, 4, v5
    s_mul_i32 s24, s20, 384
    s_add_u32 s24, s24, 7150336
    buffer_load_dwordx4 v[64:67], v5, s[12:15], s24 offen offset:0 sc1
    buffer_load_dwordx4 v[88:91], v5, s[12:15], s24 offen offset:2304 sc1
    buffer_load_dwordx4 v[68:71], v5, s[12:15], s24 offen offset:64 sc1
    buffer_load_dwordx4 v[92:95], v5, s[12:15], s24 offen offset:2368 sc1
    buffer_load_dwordx4 v[72:75], v5, s[12:15], s24 offen offset:128 sc1
    buffer_load_dwordx4 v[96:99], v5, s[12:15], s24 offen offset:2432 sc1
    buffer_load_dwordx4 v[76:79], v5, s[12:15], s24 offen offset:192 sc1
    buffer_load_dwordx4 v[100:103], v5, s[12:15], s24 offen offset:2496 sc1
    buffer_load_dwordx4 v[80:83], v5, s[12:15], s24 offen offset:256 sc1
    buffer_load_dwordx4 v[104:107], v5, s[12:15], s24 offen offset:2560 sc1
    buffer_load_dwordx4 v[84:87], v5, s[12:15], s24 offen offset:320 sc1
    buffer_load_dwordx4 v[108:111], v5, s[12:15], s24 offen offset:2624 sc1
    s_sub_u32 s23, s23, 12288
    v_lshrrev_b32 v6, 2, v0
    v_and_b32 v7, 6, v6
    v_bfe_u32 v12, v0, 1, 1
    v_xor_b32 v7, v7, v12
    v_lshlrev_b32 v7, 4, v7
    v_lshlrev_b32 v6, 7, v6
    v_and_b32 v12, 1, v0
    v_lshlrev_b32 v12, 3, v12
    v_add3_u32 v6, v6, v12, s23
    v_add_u32 v8, v6, v7
    v_xor_b32 v9, 32, v8
    v_xor_b32 v10, 64, v8
    v_xor_b32 v11, 0x60, v8
    v_lshlrev_b32 v13, 4, v0
    s_mul_i32 s25, s17, 1327104
    s_sub_u32 s26, s19, s17
    s_sub_u32 s26, s26, 1
    s_and_b32 s26, s26, 7
    s_add_u32 s26, s26, 1
    s_cmp_eq_u32 s19, 8
    s_cselect_b32 s26, 0, s26
    s_mul_i32 s26, s26, 18432
    s_add_u32 s25, s25, s26
    s_mul_i32 s26, s20, 3072
    s_add_u32 s26, s26, 165888
    s_add_u32 s25, s25, s26
    s_add_u32 s25, s25, 9830400
    s_add_u32 s26, s25, 331776
    s_add_u32 s27, s25, 663552
    s_add_u32 s28, s25, 995328
    ds_read_b64_tr_b16 v[16:17], v8 offset:0
    ds_read_b64_tr_b16 v[18:19], v8 offset:2048
    ds_read_b64_tr_b16 v[20:21], v9 offset:0
    ds_read_b64_tr_b16 v[22:23], v9 offset:2048
    ds_read_b64_tr_b16 v[24:25], v10 offset:0
    ds_read_b64_tr_b16 v[26:27], v10 offset:2048
    ds_read_b64_tr_b16 v[28:29], v11 offset:0
    ds_read_b64_tr_b16 v[30:31], v11 offset:2048
    s_waitcnt lgkmcnt(6)
    buffer_store_dwordx4 v[16:19], v13, s[12:15], s25 offen offset:0 sc1
    s_waitcnt lgkmcnt(4)
    buffer_store_dwordx4 v[20:23], v13, s[12:15], s26 offen offset:0 sc1
    s_waitcnt lgkmcnt(2)
    buffer_store_dwordx4 v[24:27], v13, s[12:15], s27 offen offset:0 sc1
    s_waitcnt lgkmcnt(0)
    buffer_store_dwordx4 v[28:31], v13, s[12:15], s28 offen offset:0 sc1
    ds_read_b64_tr_b16 v[32:33], v8 offset:4096
    ds_read_b64_tr_b16 v[34:35], v8 offset:6144
    ds_read_b64_tr_b16 v[36:37], v9 offset:4096
    ds_read_b64_tr_b16 v[38:39], v9 offset:6144
    ds_read_b64_tr_b16 v[40:41], v10 offset:4096
    ds_read_b64_tr_b16 v[42:43], v10 offset:6144
    ds_read_b64_tr_b16 v[44:45], v11 offset:4096
    ds_read_b64_tr_b16 v[46:47], v11 offset:6144
    s_waitcnt lgkmcnt(6)
    buffer_store_dwordx4 v[32:35], v13, s[12:15], s25 offen offset:1024 sc1
    s_waitcnt lgkmcnt(4)
    buffer_store_dwordx4 v[36:39], v13, s[12:15], s26 offen offset:1024 sc1
    s_waitcnt lgkmcnt(2)
    buffer_store_dwordx4 v[40:43], v13, s[12:15], s27 offen offset:1024 sc1
    s_waitcnt lgkmcnt(0)
    buffer_store_dwordx4 v[44:47], v13, s[12:15], s28 offen offset:1024 sc1
    ds_read_b64_tr_b16 v[48:49], v8 offset:8192
    ds_read_b64_tr_b16 v[50:51], v8 offset:10240
    ds_read_b64_tr_b16 v[52:53], v9 offset:8192
    ds_read_b64_tr_b16 v[54:55], v9 offset:10240
    ds_read_b64_tr_b16 v[56:57], v10 offset:8192
    ds_read_b64_tr_b16 v[58:59], v10 offset:10240
    ds_read_b64_tr_b16 v[60:61], v11 offset:8192
    ds_read_b64_tr_b16 v[62:63], v11 offset:10240
    s_waitcnt lgkmcnt(6)
    buffer_store_dwordx4 v[48:51], v13, s[12:15], s25 offen offset:2048 sc1
    s_waitcnt lgkmcnt(4)
    buffer_store_dwordx4 v[52:55], v13, s[12:15], s26 offen offset:2048 sc1
    s_waitcnt lgkmcnt(2)
    buffer_store_dwordx4 v[56:59], v13, s[12:15], s27 offen offset:2048 sc1
    s_waitcnt lgkmcnt(0)
    buffer_store_dwordx4 v[60:63], v13, s[12:15], s28 offen offset:2048 sc1
    s_add_u32 s23, s23, 12288
    v_lshrrev_b32 v6, 2, v0
    v_and_b32 v7, 6, v6
    v_bfe_u32 v12, v0, 1, 1
    v_xor_b32 v7, v7, v12
    v_lshlrev_b32 v7, 4, v7
    v_lshlrev_b32 v6, 7, v6
    v_and_b32 v12, 1, v0
    v_lshlrev_b32 v12, 3, v12
    v_add3_u32 v6, v6, v12, s23
    v_add_u32 v8, v6, v7
    v_xor_b32 v9, 32, v8
    v_xor_b32 v10, 64, v8
    v_xor_b32 v11, 0x60, v8
    v_lshlrev_b32 v13, 4, v0
    s_mul_i32 s25, s17, 1327104
    s_mul_i32 s26, s20, 27648
    s_add_u32 s25, s25, s26
    s_lshl_b32 s26, s19, 10
    v_add_u32 v14, 9216, v13
    v_add_u32 v15, 18432, v13
    s_add_u32 s25, s25, s26
    s_add_u32 s25, s25, 9830400
    s_add_u32 s26, s25, 331776
    s_add_u32 s27, s25, 663552
    s_add_u32 s28, s25, 995328
    s_waitcnt vmcnt(12)
    v_mov_b32 v112, 0x3f803f80
    v_mov_b32 v113, v112
    v_mov_b32 v114, v112
    v_mov_b32 v115, v112
    v_add_f32 v88, 1.0, v88
    v_add_f32 v89, 1.0, v89
    v_add_f32 v90, 1.0, v90
    v_add_f32 v91, 1.0, v91
    v_add_f32 v92, 1.0, v92
    v_add_f32 v93, 1.0, v93
    v_add_f32 v94, 1.0, v94
    v_add_f32 v95, 1.0, v95
    v_add_f32 v96, 1.0, v96
    v_add_f32 v97, 1.0, v97
    v_add_f32 v98, 1.0, v98
    v_add_f32 v99, 1.0, v99
    v_add_f32 v100, 1.0, v100
    v_add_f32 v101, 1.0, v101
    v_add_f32 v102, 1.0, v102
    v_add_f32 v103, 1.0, v103
    v_add_f32 v104, 1.0, v104
    v_add_f32 v105, 1.0, v105
    v_add_f32 v106, 1.0, v106
    v_add_f32 v107, 1.0, v107
    v_add_f32 v108, 1.0, v108
    v_add_f32 v109, 1.0, v109
    v_add_f32 v110, 1.0, v110
    v_add_f32 v111, 1.0, v111
    v_cvt_pk_bf16_f32 v116, v64, v65
    v_cvt_pk_bf16_f32 v117, v66, v67
    v_cvt_pk_bf16_f32 v118, v68, v69
    v_cvt_pk_bf16_f32 v119, v70, v71
    v_cvt_pk_bf16_f32 v120, v72, v73
    v_cvt_pk_bf16_f32 v121, v74, v75
    v_cvt_pk_bf16_f32 v122, v76, v77
    v_cvt_pk_bf16_f32 v123, v78, v79
    v_cvt_pk_bf16_f32 v124, v80, v81
    v_cvt_pk_bf16_f32 v125, v82, v83
    v_cvt_pk_bf16_f32 v126, v84, v85
    v_cvt_pk_bf16_f32 v127, v86, v87
    v_cvt_pk_bf16_f32 v64, v88, v89
    v_cvt_pk_bf16_f32 v65, v90, v91
    v_cvt_pk_bf16_f32 v66, v92, v93
    v_cvt_pk_bf16_f32 v67, v94, v95
    v_cvt_pk_bf16_f32 v68, v96, v97
    v_cvt_pk_bf16_f32 v69, v98, v99
    v_cvt_pk_bf16_f32 v70, v100, v101
    v_cvt_pk_bf16_f32 v71, v102, v103
    v_cvt_pk_bf16_f32 v72, v104, v105
    v_cvt_pk_bf16_f32 v73, v106, v107
    v_cvt_pk_bf16_f32 v74, v108, v109
    v_cvt_pk_bf16_f32 v75, v110, v111
    v_lshlrev_b32 v88, 16, v64
    v_and_b32 v89, 0xffff0000, v64
    v_lshlrev_b32 v90, 16, v65
    v_and_b32 v91, 0xffff0000, v65
    v_lshlrev_b32 v92, 16, v66
    v_and_b32 v93, 0xffff0000, v66
    v_lshlrev_b32 v94, 16, v67
    v_and_b32 v95, 0xffff0000, v67
    v_lshlrev_b32 v96, 16, v68
    v_and_b32 v97, 0xffff0000, v68
    v_lshlrev_b32 v98, 16, v69
    v_and_b32 v99, 0xffff0000, v69
    v_lshlrev_b32 v100, 16, v70
    v_and_b32 v101, 0xffff0000, v70
    v_lshlrev_b32 v102, 16, v71
    v_and_b32 v103, 0xffff0000, v71
    v_lshlrev_b32 v104, 16, v72
    v_and_b32 v105, 0xffff0000, v72
    v_lshlrev_b32 v106, 16, v73
    v_and_b32 v107, 0xffff0000, v73
    v_lshlrev_b32 v108, 16, v74
    v_and_b32 v109, 0xffff0000, v74
    v_lshlrev_b32 v110, 16, v75
    v_and_b32 v111, 0xffff0000, v75
    ds_read_b64_tr_b16 v[16:17], v8 offset:0
    ds_read_b64_tr_b16 v[18:19], v8 offset:2048
    ds_read_b64_tr_b16 v[20:21], v9 offset:0
    ds_read_b64_tr_b16 v[22:23], v9 offset:2048
    ds_read_b64_tr_b16 v[24:25], v10 offset:0
    ds_read_b64_tr_b16 v[26:27], v10 offset:2048
    ds_read_b64_tr_b16 v[28:29], v11 offset:0
    ds_read_b64_tr_b16 v[30:31], v11 offset:2048
    s_waitcnt lgkmcnt(6)
    v_mfma_f32_16x16x32_bf16 v[128:131], v[116:119], v[16:19], 0
    v_lshlrev_b32 v64, 16, v16
    v_and_b32 v65, 0xffff0000, v16
    v_lshlrev_b32 v66, 16, v17
    v_and_b32 v67, 0xffff0000, v17
    v_lshlrev_b32 v68, 16, v18
    v_and_b32 v69, 0xffff0000, v18
    v_lshlrev_b32 v70, 16, v19
    v_and_b32 v71, 0xffff0000, v19
    v_pk_mul_f32 v[64:65], v[64:65], v[88:89]
    v_pk_mul_f32 v[66:67], v[66:67], v[90:91]
    v_pk_mul_f32 v[68:69], v[68:69], v[92:93]
    v_pk_mul_f32 v[70:71], v[70:71], v[94:95]
    v_cvt_pk_bf16_f32 v16, v64, v65
    v_cvt_pk_bf16_f32 v17, v66, v67
    v_cvt_pk_bf16_f32 v18, v68, v69
    v_cvt_pk_bf16_f32 v19, v70, v71
    buffer_store_dwordx4 v[16:19], v13, s[12:15], s25 offen sc1
    s_nop 0
    v_mfma_f32_16x16x32_bf16 v[144:147], v[112:115], v[16:19], 0
    s_waitcnt lgkmcnt(4)
    v_mfma_f32_16x16x32_bf16 v[132:135], v[116:119], v[20:23], 0
    v_lshlrev_b32 v72, 16, v20
    v_and_b32 v73, 0xffff0000, v20
    v_lshlrev_b32 v74, 16, v21
    v_and_b32 v75, 0xffff0000, v21
    v_lshlrev_b32 v76, 16, v22
    v_and_b32 v77, 0xffff0000, v22
    v_lshlrev_b32 v78, 16, v23
    v_and_b32 v79, 0xffff0000, v23
    v_pk_mul_f32 v[72:73], v[72:73], v[88:89]
    v_pk_mul_f32 v[74:75], v[74:75], v[90:91]
    v_pk_mul_f32 v[76:77], v[76:77], v[92:93]
    v_pk_mul_f32 v[78:79], v[78:79], v[94:95]
    v_cvt_pk_bf16_f32 v20, v72, v73
    v_cvt_pk_bf16_f32 v21, v74, v75
    v_cvt_pk_bf16_f32 v22, v76, v77
    v_cvt_pk_bf16_f32 v23, v78, v79
    buffer_store_dwordx4 v[20:23], v13, s[12:15], s26 offen sc1
    s_nop 0
    v_mfma_f32_16x16x32_bf16 v[148:151], v[112:115], v[20:23], 0
    s_waitcnt lgkmcnt(2)
    v_mfma_f32_16x16x32_bf16 v[136:139], v[116:119], v[24:27], 0
    v_lshlrev_b32 v64, 16, v24
    v_and_b32 v65, 0xffff0000, v24
    v_lshlrev_b32 v66, 16, v25
    v_and_b32 v67, 0xffff0000, v25
    v_lshlrev_b32 v68, 16, v26
    v_and_b32 v69, 0xffff0000, v26
    v_lshlrev_b32 v70, 16, v27
    v_and_b32 v71, 0xffff0000, v27
    v_pk_mul_f32 v[64:65], v[64:65], v[88:89]
    v_pk_mul_f32 v[66:67], v[66:67], v[90:91]
    v_pk_mul_f32 v[68:69], v[68:69], v[92:93]
    v_pk_mul_f32 v[70:71], v[70:71], v[94:95]
    v_cvt_pk_bf16_f32 v24, v64, v65
    v_cvt_pk_bf16_f32 v25, v66, v67
    v_cvt_pk_bf16_f32 v26, v68, v69
    v_cvt_pk_bf16_f32 v27, v70, v71
    buffer_store_dwordx4 v[24:27], v13, s[12:15], s27 offen sc1
    s_nop 0
    v_mfma_f32_16x16x32_bf16 v[152:155], v[112:115], v[24:27], 0
    s_waitcnt lgkmcnt(0)
    v_mfma_f32_16x16x32_bf16 v[140:143], v[116:119], v[28:31], 0
    v_lshlrev_b32 v72, 16, v28
    v_and_b32 v73, 0xffff0000, v28
    v_lshlrev_b32 v74, 16, v29
    v_and_b32 v75, 0xffff0000, v29
    v_lshlrev_b32 v76, 16, v30
    v_and_b32 v77, 0xffff0000, v30
    v_lshlrev_b32 v78, 16, v31
    v_and_b32 v79, 0xffff0000, v31
    v_pk_mul_f32 v[72:73], v[72:73], v[88:89]
    v_pk_mul_f32 v[74:75], v[74:75], v[90:91]
    v_pk_mul_f32 v[76:77], v[76:77], v[92:93]
    v_pk_mul_f32 v[78:79], v[78:79], v[94:95]
    v_cvt_pk_bf16_f32 v28, v72, v73
    v_cvt_pk_bf16_f32 v29, v74, v75
    v_cvt_pk_bf16_f32 v30, v76, v77
    v_cvt_pk_bf16_f32 v31, v78, v79
    buffer_store_dwordx4 v[28:31], v13, s[12:15], s28 offen sc1
    s_nop 0
    v_mfma_f32_16x16x32_bf16 v[156:159], v[112:115], v[28:31], 0
    ds_read_b64_tr_b16 v[32:33], v8 offset:4096
    ds_read_b64_tr_b16 v[34:35], v8 offset:6144
    ds_read_b64_tr_b16 v[36:37], v9 offset:4096
    ds_read_b64_tr_b16 v[38:39], v9 offset:6144
    ds_read_b64_tr_b16 v[40:41], v10 offset:4096
    ds_read_b64_tr_b16 v[42:43], v10 offset:6144
    ds_read_b64_tr_b16 v[44:45], v11 offset:4096
    ds_read_b64_tr_b16 v[46:47], v11 offset:6144
    s_waitcnt lgkmcnt(6)
    v_mfma_f32_16x16x32_bf16 v[128:131], v[120:123], v[32:35], v[128:131]
    v_lshlrev_b32 v64, 16, v32
    v_and_b32 v65, 0xffff0000, v32
    v_lshlrev_b32 v66, 16, v33
    v_and_b32 v67, 0xffff0000, v33
    v_lshlrev_b32 v68, 16, v34
    v_and_b32 v69, 0xffff0000, v34
    v_lshlrev_b32 v70, 16, v35
    v_and_b32 v71, 0xffff0000, v35
    v_pk_mul_f32 v[64:65], v[64:65], v[96:97]
    v_pk_mul_f32 v[66:67], v[66:67], v[98:99]
    v_pk_mul_f32 v[68:69], v[68:69], v[100:101]
    v_pk_mul_f32 v[70:71], v[70:71], v[102:103]
    v_cvt_pk_bf16_f32 v32, v64, v65
    v_cvt_pk_bf16_f32 v33, v66, v67
    v_cvt_pk_bf16_f32 v34, v68, v69
    v_cvt_pk_bf16_f32 v35, v70, v71
    buffer_store_dwordx4 v[32:35], v14, s[12:15], s25 offen sc1
    s_nop 0
    v_mfma_f32_16x16x32_bf16 v[144:147], v[112:115], v[32:35], v[144:147]
    s_waitcnt lgkmcnt(4)
    v_mfma_f32_16x16x32_bf16 v[132:135], v[120:123], v[36:39], v[132:135]
    v_lshlrev_b32 v72, 16, v36
    v_and_b32 v73, 0xffff0000, v36
    v_lshlrev_b32 v74, 16, v37
    v_and_b32 v75, 0xffff0000, v37
    v_lshlrev_b32 v76, 16, v38
    v_and_b32 v77, 0xffff0000, v38
    v_lshlrev_b32 v78, 16, v39
    v_and_b32 v79, 0xffff0000, v39
    v_pk_mul_f32 v[72:73], v[72:73], v[96:97]
    v_pk_mul_f32 v[74:75], v[74:75], v[98:99]
    v_pk_mul_f32 v[76:77], v[76:77], v[100:101]
    v_pk_mul_f32 v[78:79], v[78:79], v[102:103]
    v_cvt_pk_bf16_f32 v36, v72, v73
    v_cvt_pk_bf16_f32 v37, v74, v75
    v_cvt_pk_bf16_f32 v38, v76, v77
    v_cvt_pk_bf16_f32 v39, v78, v79
    buffer_store_dwordx4 v[36:39], v14, s[12:15], s26 offen sc1
    s_nop 0
    v_mfma_f32_16x16x32_bf16 v[148:151], v[112:115], v[36:39], v[148:151]
    s_waitcnt lgkmcnt(2)
    v_mfma_f32_16x16x32_bf16 v[136:139], v[120:123], v[40:43], v[136:139]
    v_lshlrev_b32 v64, 16, v40
    v_and_b32 v65, 0xffff0000, v40
    v_lshlrev_b32 v66, 16, v41
    v_and_b32 v67, 0xffff0000, v41
    v_lshlrev_b32 v68, 16, v42
    v_and_b32 v69, 0xffff0000, v42
    v_lshlrev_b32 v70, 16, v43
    v_and_b32 v71, 0xffff0000, v43
    v_pk_mul_f32 v[64:65], v[64:65], v[96:97]
    v_pk_mul_f32 v[66:67], v[66:67], v[98:99]
    v_pk_mul_f32 v[68:69], v[68:69], v[100:101]
    v_pk_mul_f32 v[70:71], v[70:71], v[102:103]
    v_cvt_pk_bf16_f32 v40, v64, v65
    v_cvt_pk_bf16_f32 v41, v66, v67
    v_cvt_pk_bf16_f32 v42, v68, v69
    v_cvt_pk_bf16_f32 v43, v70, v71
    buffer_store_dwordx4 v[40:43], v14, s[12:15], s27 offen sc1
    s_nop 0
    v_mfma_f32_16x16x32_bf16 v[152:155], v[112:115], v[40:43], v[152:155]
    s_waitcnt lgkmcnt(0)
    v_mfma_f32_16x16x32_bf16 v[140:143], v[120:123], v[44:47], v[140:143]
    v_lshlrev_b32 v72, 16, v44
    v_and_b32 v73, 0xffff0000, v44
    v_lshlrev_b32 v74, 16, v45
    v_and_b32 v75, 0xffff0000, v45
    v_lshlrev_b32 v76, 16, v46
    v_and_b32 v77, 0xffff0000, v46
    v_lshlrev_b32 v78, 16, v47
    v_and_b32 v79, 0xffff0000, v47
    v_pk_mul_f32 v[72:73], v[72:73], v[96:97]
    v_pk_mul_f32 v[74:75], v[74:75], v[98:99]
    v_pk_mul_f32 v[76:77], v[76:77], v[100:101]
    v_pk_mul_f32 v[78:79], v[78:79], v[102:103]
    v_cvt_pk_bf16_f32 v44, v72, v73
    v_cvt_pk_bf16_f32 v45, v74, v75
    v_cvt_pk_bf16_f32 v46, v76, v77
    v_cvt_pk_bf16_f32 v47, v78, v79
    buffer_store_dwordx4 v[44:47], v14, s[12:15], s28 offen sc1
    s_nop 0
    v_mfma_f32_16x16x32_bf16 v[156:159], v[112:115], v[44:47], v[156:159]
    ds_read_b64_tr_b16 v[48:49], v8 offset:8192
    ds_read_b64_tr_b16 v[50:51], v8 offset:10240
    ds_read_b64_tr_b16 v[52:53], v9 offset:8192
    ds_read_b64_tr_b16 v[54:55], v9 offset:10240
    ds_read_b64_tr_b16 v[56:57], v10 offset:8192
    ds_read_b64_tr_b16 v[58:59], v10 offset:10240
    ds_read_b64_tr_b16 v[60:61], v11 offset:8192
    ds_read_b64_tr_b16 v[62:63], v11 offset:10240
    s_waitcnt lgkmcnt(6)
    v_mfma_f32_16x16x32_bf16 v[128:131], v[124:127], v[48:51], v[128:131]
    v_lshlrev_b32 v64, 16, v48
    v_and_b32 v65, 0xffff0000, v48
    v_lshlrev_b32 v66, 16, v49
    v_and_b32 v67, 0xffff0000, v49
    v_lshlrev_b32 v68, 16, v50
    v_and_b32 v69, 0xffff0000, v50
    v_lshlrev_b32 v70, 16, v51
    v_and_b32 v71, 0xffff0000, v51
    v_pk_mul_f32 v[64:65], v[64:65], v[104:105]
    v_pk_mul_f32 v[66:67], v[66:67], v[106:107]
    v_pk_mul_f32 v[68:69], v[68:69], v[108:109]
    v_pk_mul_f32 v[70:71], v[70:71], v[110:111]
    v_cvt_pk_bf16_f32 v48, v64, v65
    v_cvt_pk_bf16_f32 v49, v66, v67
    v_cvt_pk_bf16_f32 v50, v68, v69
    v_cvt_pk_bf16_f32 v51, v70, v71
    buffer_store_dwordx4 v[48:51], v15, s[12:15], s25 offen sc1
    s_nop 0
    v_mfma_f32_16x16x32_bf16 v[144:147], v[112:115], v[48:51], v[144:147]
    s_waitcnt lgkmcnt(4)
    v_mfma_f32_16x16x32_bf16 v[132:135], v[124:127], v[52:55], v[132:135]
    v_lshlrev_b32 v72, 16, v52
    v_and_b32 v73, 0xffff0000, v52
    v_lshlrev_b32 v74, 16, v53
    v_and_b32 v75, 0xffff0000, v53
    v_lshlrev_b32 v76, 16, v54
    v_and_b32 v77, 0xffff0000, v54
    v_lshlrev_b32 v78, 16, v55
    v_and_b32 v79, 0xffff0000, v55
    v_pk_mul_f32 v[72:73], v[72:73], v[104:105]
    v_pk_mul_f32 v[74:75], v[74:75], v[106:107]
    v_pk_mul_f32 v[76:77], v[76:77], v[108:109]
    v_pk_mul_f32 v[78:79], v[78:79], v[110:111]
    v_cvt_pk_bf16_f32 v52, v72, v73
    v_cvt_pk_bf16_f32 v53, v74, v75
    v_cvt_pk_bf16_f32 v54, v76, v77
    v_cvt_pk_bf16_f32 v55, v78, v79
    buffer_store_dwordx4 v[52:55], v15, s[12:15], s26 offen sc1
    s_nop 0
    v_mfma_f32_16x16x32_bf16 v[148:151], v[112:115], v[52:55], v[148:151]
    s_waitcnt lgkmcnt(2)
    v_mfma_f32_16x16x32_bf16 v[136:139], v[124:127], v[56:59], v[136:139]
    v_lshlrev_b32 v64, 16, v56
    v_and_b32 v65, 0xffff0000, v56
    v_lshlrev_b32 v66, 16, v57
    v_and_b32 v67, 0xffff0000, v57
    v_lshlrev_b32 v68, 16, v58
    v_and_b32 v69, 0xffff0000, v58
    v_lshlrev_b32 v70, 16, v59
    v_and_b32 v71, 0xffff0000, v59
    v_pk_mul_f32 v[64:65], v[64:65], v[104:105]
    v_pk_mul_f32 v[66:67], v[66:67], v[106:107]
    v_pk_mul_f32 v[68:69], v[68:69], v[108:109]
    v_pk_mul_f32 v[70:71], v[70:71], v[110:111]
    v_cvt_pk_bf16_f32 v56, v64, v65
    v_cvt_pk_bf16_f32 v57, v66, v67
    v_cvt_pk_bf16_f32 v58, v68, v69
    v_cvt_pk_bf16_f32 v59, v70, v71
    buffer_store_dwordx4 v[56:59], v15, s[12:15], s27 offen sc1
    s_nop 0
    v_mfma_f32_16x16x32_bf16 v[152:155], v[112:115], v[56:59], v[152:155]
    s_waitcnt lgkmcnt(0)
    v_mfma_f32_16x16x32_bf16 v[140:143], v[124:127], v[60:63], v[140:143]
    v_lshlrev_b32 v72, 16, v60
    v_and_b32 v73, 0xffff0000, v60
    v_lshlrev_b32 v74, 16, v61
    v_and_b32 v75, 0xffff0000, v61
    v_lshlrev_b32 v76, 16, v62
    v_and_b32 v77, 0xffff0000, v62
    v_lshlrev_b32 v78, 16, v63
    v_and_b32 v79, 0xffff0000, v63
    v_pk_mul_f32 v[72:73], v[72:73], v[104:105]
    v_pk_mul_f32 v[74:75], v[74:75], v[106:107]
    v_pk_mul_f32 v[76:77], v[76:77], v[108:109]
    v_pk_mul_f32 v[78:79], v[78:79], v[110:111]
    v_cvt_pk_bf16_f32 v60, v72, v73
    v_cvt_pk_bf16_f32 v61, v74, v75
    v_cvt_pk_bf16_f32 v62, v76, v77
    v_cvt_pk_bf16_f32 v63, v78, v79
    buffer_store_dwordx4 v[60:63], v15, s[12:15], s28 offen sc1
    s_nop 0
    v_mfma_f32_16x16x32_bf16 v[156:159], v[112:115], v[60:63], v[156:159]
    v_mul_u32_u24 v6, 576, v5
    v_and_b32 v7, 15, v0
    v_lshl_add_u32 v6, v7, 4, v6
    v_cmp_eq_u32 s[30:31], 16, v5
    v_cmp_eq_u32 s[32:33], 32, v5
    v_cmp_eq_u32 s[34:35], 48, v5
    s_mul_i32 s24, s20, 3072
    s_cmp_ge_u32 s20, 3
    s_cselect_b32 s25, 8704, 0
    s_sub_u32 s24, s24, s25
    s_mul_i32 s25, s17, 36864
    s_add_u32 s24, s24, s25
    s_lshr_b32 s25, s19, 2
    s_mul_i32 s25, s25, 1008
    s_add_u32 s24, s24, s25
    s_lshl_b32 s25, s19, 2
    s_add_u32 s24, s24, s25
    s_add_u32 s24, s24, 39452672
    s_add_u32 s25, s24, 256
    v_cndmask_b32 v128, v128, v132, s[30:31]
    v_cndmask_b32 v128, v128, v136, s[32:33]
    v_cndmask_b32 v128, v128, v140, s[34:35]
    v_cndmask_b32 v144, v144, v148, s[30:31]
    v_cndmask_b32 v144, v144, v152, s[32:33]
    v_cndmask_b32 v144, v144, v156, s[34:35]
    buffer_store_dword v128, v6, s[12:15], s25 offen sc1
    buffer_store_dword v144, v6, s[12:15], s24 offen sc1
F_exit2:
    s_endpgm
F_sp:
    s_waitcnt vmcnt(0)
    s_branch F_ln
F_exit:
    s_endpgm

.section .rodata,"a"
.p2align 6
.amdhsa_kernel front_kernel
  .amdhsa_next_free_vgpr 256
  .amdhsa_next_free_sgpr 64
  .amdhsa_accum_offset 256
  .amdhsa_group_segment_fixed_size 0
  .amdhsa_kernarg_size 120
  .amdhsa_user_sgpr_count 2
  .amdhsa_user_sgpr_kernarg_segment_ptr 1
  .amdhsa_system_sgpr_workgroup_id_x 1
.end_amdhsa_kernel
.text
.globl ffn_kernel
.p2align 8
.type ffn_kernel,@function
ffn_kernel:
    s_cmp_ge_u32 s2, 256
    s_cbranch_scc1 C_exit
    s_load_dwordx2 s[12:13], s[0:1], 112
    s_load_dwordx2 s[8:9], s[0:1], 96
    v_lshrrev_b32 v1, 6, v0
    v_and_b32 v0, 63, v0
    v_readfirstlane_b32 s16, v1
    s_and_b32 s17, s2, 7
    s_lshr_b32 s18, s2, 3
    s_getpc_b64 s[4:5]
    s_lshl_b32 s6, s16, 13
    v_lshl_add_u32 v1, v0, 7, s6
    v_min_u32 v1, C_exit-ffn_kernel-64, v1
    s_cmp_ge_u32 s18, 2
    s_cbranch_scc1 C_nopf
    global_load_dword v1, v1, s[4:5]
C_nopf:
    s_waitcnt lgkmcnt(0)
    s_mov_b32 s14, 0x10000000
    s_mov_b32 s15, 0x20000
    s_mov_b32 s10, 0x240000
    s_mov_b32 s11, 0x20000
    v_lshlrev_b32 v2, 4, v0
    s_mul_i32 s20, s18, 73728
    s_lshl_b32 s24, s16, 10
    s_mov_b32 m0, s24
    s_add_u32 s20, s20, s24
    s_add_u32 s20, s20, 7471104
    s_lshl_b32 s30, s17, 2
    s_add_u32 s30, s30, s16
    s_mul_i32 s28, s30, 331776
    s_add_u32 s28, s28, 9826304
    buffer_load_dwordx4 v2, s[12:15], s20 offen lds
    s_add_u32 m0, m0, 4096
    s_add_u32 s20, s20, 4096
    buffer_load_dwordx4 v2, s[12:15], s20 offen lds
    s_add_u32 m0, m0, 4096
    s_add_u32 s20, s20, 4096
    s_add_u32 s28, s28, 4096
    buffer_load_dwordx4 a[0:3], v2, s[12:15], s28 offen offset:0
    buffer_load_dwordx4 a[4:7], v2, s[12:15], s28 offen offset:1024
    buffer_load_dwordx4 a[8:11], v2, s[12:15], s28 offen offset:2048
    buffer_load_dwordx4 a[12:15], v2, s[12:15], s28 offen offset:3072
    s_add_u32 s28, s28, 4096
    buffer_load_dwordx4 a[16:19], v2, s[12:15], s28 offen offset:0
    buffer_load_dwordx4 a[20:23], v2, s[12:15], s28 offen offset:1024
    buffer_load_dwordx4 a[24:27], v2, s[12:15], s28 offen offset:2048
    buffer_load_dwordx4 a[28:31], v2, s[12:15], s28 offen offset:3072
    s_add_u32 s28, s28, 4096
    buffer_load_dwordx4 a[32:35], v2, s[12:15], s28 offen offset:0
    buffer_load_dwordx4 v2, s[12:15], s20 offen lds
    s_add_u32 m0, m0, 4096
    s_add_u32 s20, s20, 4096
    buffer_load_dwordx4 a[36:39], v2, s[12:15], s28 offen offset:1024
    buffer_load_dwordx4 a[40:43], v2, s[12:15], s28 offen offset:2048
    buffer_load_dwordx4 a[44:47], v2, s[12:15], s28 offen offset:3072
    s_add_u32 s28, s28, 4096
    buffer_load_dwordx4 a[48:51], v2, s[12:15], s28 offen offset:0
    buffer_load_dwordx4 a[52:55], v2, s[12:15], s28 offen offset:1024
    buffer_load_dwordx4 a[56:59], v2, s[12:15], s28 offen offset:2048
    buffer_load_dwordx4 a[60:63], v2, s[12:15], s28 offen offset:3072
    s_add_u32 s28, s28, 4096
    buffer_load_dwordx4 a[64:67], v2, s[12:15], s28 offen offset:0
    buffer_load_dwordx4 a[68:71], v2, s[12:15], s28 offen offset:1024
    v_lshrrev_b32 v3, 2, v0
    v_mov_b32 v6, 0x80000000
    s_lshl_b32 s24, s16, 6
    v_lshrrev_b32 v7, 4, v0
    v_lshlrev_b32 v8, 4, v7
    s_lshr_b32 s25, s17, 1
    s_lshl_b32 s25, s25, 6
    s_and_b32 s26, s16, 1
    s_lshl_b32 s27, s26, 3
    v_and_b32 v9, 6, v3
    v_bfe_u32 v5, v0, 1, 1
    v_xor_b32 v9, v9, v5
    v_lshlrev_b32 v9, 4, v9
    v_lshl_add_u32 v9, v3, 7, v9
    v_and_b32 v5, 1, v0
    v_lshl_add_u32 v9, v5, 3, v9
    s_lshr_b32 s29, s16, 1
    s_lshl_b32 s29, s29, 12
    s_add_u32 s29, s29, s27
    s_add_u32 s29, s29, 73728
    v_and_b32 v5, 15, v0
    v_and_b32 v27, 1, v7
    v_lshlrev_b32 v26, 4, v5
    v_lshl_add_u32 v25, v27, 2, v26
    s_mul_i32 s23, s30, 9216
    s_add_u32 s23, s23, 39452672
    s_add_u32 s36, s16, 0
    s_and_b32 s36, s36, 3
    s_lshl_b32 s31, s36, 5
    v_xor_b32 v10, s31, v9
    s_lshl_b32 s31, s36, 10
    s_add_u32 s31, s31, s29
    v_add_u32 v14, s31, v2
    s_lshl_b32 s31, s36, 8
    s_add_u32 s31, s31, 147456
    v_add_u32 v18, s31, v25
    s_add_u32 s36, s16, 1
    s_and_b32 s36, s36, 3
    s_lshl_b32 s31, s36, 5
    v_xor_b32 v11, s31, v9
    s_lshl_b32 s31, s36, 10
    s_add_u32 s31, s31, s29
    v_add_u32 v15, s31, v2
    s_lshl_b32 s31, s36, 8
    s_add_u32 s31, s31, 147456
    v_add_u32 v19, s31, v25
    s_add_u32 s36, s16, 2
    s_and_b32 s36, s36, 3
    s_lshl_b32 s31, s36, 5
    v_xor_b32 v12, s31, v9
    s_lshl_b32 s31, s36, 10
    s_add_u32 s31, s31, s29
    v_add_u32 v16, s31, v2
    s_lshl_b32 s31, s36, 8
    s_add_u32 s31, s31, 147456
    v_add_u32 v20, s31, v25
    s_add_u32 s36, s16, 3
    s_and_b32 s36, s36, 3
    s_lshl_b32 s31, s36, 5
    v_xor_b32 v13, s31, v9
    s_lshl_b32 s31, s36, 10
    s_add_u32 s31, s31, s29
    v_add_u32 v17, s31, v2
    s_lshl_b32 s31, s36, 8
    s_add_u32 s31, s31, 147456
    v_add_u32 v21, s31, v25
    v_add_u32 v23, 73728, v2
    v_cmp_eq_u32 vcc, 0, v0
    v_mov_b32 v4, 1
    s_mov_b32 s37, 3
    v_cndmask_b32 v3, v6, v0, vcc
    v_mov_b32 v40, 0x3f803f80
    v_mov_b32 v41, 0x3f803f80
    v_mov_b32 v42, 0x3f803f80
    v_mov_b32 v43, 0x3f803f80
    v_mov_b32 v32, 0
    v_mov_b32 v33, 0
    v_mov_b32 v34, 0
    v_mov_b32 v35, 0
    v_mov_b32 v36, 0
    v_mov_b32 v37, 0
    v_mov_b32 v38, 0
    v_mov_b32 v39, 0
    buffer_load_dwordx4 v2, s[12:15], s20 offen lds
    s_add_u32 m0, m0, 4096
    s_add_u32 s20, s20, 4096
    buffer_load_dwordx4 a[72:75], v2, s[12:15], s28 offen offset:2048
    v_mov_b32 v112, 0
    v_mov_b32 v113, 0
    v_mov_b32 v114, 0
    v_mov_b32 v115, 0
    v_mov_b32 v116, 0
    v_mov_b32 v117, 0
    v_mov_b32 v118, 0
    v_mov_b32 v119, 0
    buffer_load_dwordx4 a[76:79], v2, s[12:15], s28 offen offset:3072
    v_mov_b32 v120, 0
    v_mov_b32 v121, 0
    v_mov_b32 v122, 0
    v_mov_b32 v123, 0
    v_mov_b32 v124, 0
    v_mov_b32 v125, 0
    v_mov_b32 v126, 0
    v_mov_b32 v127, 0
    s_add_u32 s28, s28, 4096
    buffer_load_dwordx4 a[80:83], v2, s[12:15], s28 offen offset:0
    v_mov_b32 v128, 0
    v_mov_b32 v129, 0
    v_mov_b32 v130, 0
    v_mov_b32 v131, 0
    v_mov_b32 v132, 0
    v_mov_b32 v133, 0
    v_mov_b32 v134, 0
    v_mov_b32 v135, 0
    buffer_load_dwordx4 a[84:87], v2, s[12:15], s28 offen offset:1024
    v_mov_b32 v136, 0
    v_mov_b32 v137, 0
    v_mov_b32 v138, 0
    v_mov_b32 v139, 0
    v_mov_b32 v140, 0
    v_mov_b32 v141, 0
    v_mov_b32 v142, 0
    v_mov_b32 v143, 0
    buffer_load_dwordx4 a[88:91], v2, s[12:15], s28 offen offset:2048
    v_mov_b32 v144, 0
    v_mov_b32 v145, 0
    v_mov_b32 v146, 0
    v_mov_b32 v147, 0
    v_mov_b32 v148, 0
    v_mov_b32 v149, 0
    v_mov_b32 v150, 0
    v_mov_b32 v151, 0
    buffer_load_dwordx4 a[92:95], v2, s[12:15], s28 offen offset:3072
    v_mov_b32 v152, 0
    v_mov_b32 v153, 0
    v_mov_b32 v154, 0
    v_mov_b32 v155, 0
    v_mov_b32 v156, 0
    v_mov_b32 v157, 0
    v_mov_b32 v158, 0
    v_mov_b32 v159, 0
    s_add_u32 s28, s28, 4096
    buffer_load_dwordx4 a[96:99], v2, s[12:15], s28 offen offset:0
    v_mov_b32 v160, 0
    v_mov_b32 v161, 0
    v_mov_b32 v162, 0
    v_mov_b32 v163, 0
    v_mov_b32 v164, 0
    v_mov_b32 v165, 0
    v_mov_b32 v166, 0
    v_mov_b32 v167, 0
    buffer_load_dwordx4 a[100:103], v2, s[12:15], s28 offen offset:1024
    v_mov_b32 v168, 0
    v_mov_b32 v169, 0
    v_mov_b32 v170, 0
    v_mov_b32 v171, 0
    v_mov_b32 v172, 0
    v_mov_b32 v173, 0
    v_mov_b32 v174, 0
    v_mov_b32 v175, 0
    buffer_load_dwordx4 a[104:107], v2, s[12:15], s28 offen offset:2048
    v_mov_b32 v176, 0
    v_mov_b32 v177, 0
    v_mov_b32 v178, 0
    v_mov_b32 v179, 0
    v_mov_b32 v180, 0
    v_mov_b32 v181, 0
    v_mov_b32 v182, 0
    v_mov_b32 v183, 0
    buffer_load_dwordx4 v2, s[12:15], s20 offen lds
    s_add_u32 m0, m0, 4096
    s_add_u32 s20, s20, 4096
    buffer_load_dwordx4 a[108:111], v2, s[12:15], s28 offen offset:3072
    v_mov_b32 v184, 0
    v_mov_b32 v185, 0
    v_mov_b32 v186, 0
    v_mov_b32 v187, 0
    v_mov_b32 v188, 0
    v_mov_b32 v189, 0
    v_mov_b32 v190, 0
    v_mov_b32 v191, 0
    s_add_u32 s28, s28, 4096
    buffer_load_dwordx4 a[112:115], v2, s[12:15], s28 offen offset:0
    v_mov_b32 v192, 0
    v_mov_b32 v193, 0
    v_mov_b32 v194, 0
    v_mov_b32 v195, 0
    v_mov_b32 v196, 0
    v_mov_b32 v197, 0
    v_mov_b32 v198, 0
    v_mov_b32 v199, 0
    buffer_load_dwordx4 a[116:119], v2, s[12:15], s28 offen offset:1024
    v_mov_b32 v200, 0
    v_mov_b32 v201, 0
    v_mov_b32 v202, 0
    v_mov_b32 v203, 0
    v_mov_b32 v204, 0
    v_mov_b32 v205, 0
    v_mov_b32 v206, 0
    v_mov_b32 v207, 0
    buffer_load_dwordx4 a[120:123], v2, s[12:15], s28 offen offset:2048
    v_mov_b32 v208, 0
    v_mov_b32 v209, 0
    v_mov_b32 v210, 0
    v_mov_b32 v211, 0
    v_mov_b32 v212, 0
    v_mov_b32 v213, 0
    v_mov_b32 v214, 0
    v_mov_b32 v215, 0
    buffer_load_dwordx4 a[124:127], v2, s[12:15], s28 offen offset:3072
    v_mov_b32 v216, 0
    v_mov_b32 v217, 0
    v_mov_b32 v218, 0
    v_mov_b32 v219, 0
    v_mov_b32 v220, 0
    v_mov_b32 v221, 0
    v_mov_b32 v222, 0
    v_mov_b32 v223, 0
    s_add_u32 s28, s28, 4096
    buffer_load_dwordx4 a[128:131], v2, s[12:15], s28 offen offset:0
    v_mov_b32 v224, 0
    v_mov_b32 v225, 0
    v_mov_b32 v226, 0
    v_mov_b32 v227, 0
    v_mov_b32 v228, 0
    v_mov_b32 v229, 0
    v_mov_b32 v230, 0
    v_mov_b32 v231, 0
    buffer_load_dwordx4 a[132:135], v2, s[12:15], s28 offen offset:1024
    v_mov_b32 v232, 0
    v_mov_b32 v233, 0
    v_mov_b32 v234, 0
    v_mov_b32 v235, 0
    v_mov_b32 v236, 0
    v_mov_b32 v237, 0
    v_mov_b32 v238, 0
    v_mov_b32 v239, 0
    buffer_load_dwordx4 a[136:139], v2, s[12:15], s28 offen offset:2048
    v_mov_b32 v240, 0
    v_mov_b32 v241, 0
    v_mov_b32 v242, 0
    v_mov_b32 v243, 0
    v_mov_b32 v244, 0
    v_mov_b32 v245, 0
    v_mov_b32 v246, 0
    v_mov_b32 v247, 0
    buffer_load_dwordx4 a[140:143], v2, s[12:15], s28 offen offset:3072
    v_mov_b32 v248, 0
    v_mov_b32 v249, 0
    v_mov_b32 v250, 0
    v_mov_b32 v251, 0
    v_mov_b32 v252, 0
    v_mov_b32 v253, 0
    v_mov_b32 v254, 0
    v_mov_b32 v255, 0
    buffer_load_dwordx4 v2, s[12:15], s20 offen lds
    s_add_u32 m0, m0, 4096
    s_add_u32 s20, s20, 4096
    s_mul_i32 s40, s18, 589824
    s_lshl_b32 s42, s30, 11
    s_add_u32 s40, s40, s42
    s_add_u32 s40, s40, 20447232
    s_waitcnt vmcnt(41)
    s_barrier
    ds_read_b64_tr_b16 a[144:145], v10 offset:0
    ds_read_b64_tr_b16 a[146:147], v10 offset:2048
    ds_read_b64_tr_b16 a[148:149], v11 offset:0
    ds_read_b64_tr_b16 a[150:151], v11 offset:2048
    ds_read_b64_tr_b16 a[152:153], v12 offset:0
    ds_read_b64_tr_b16 a[154:155], v12 offset:2048
    ds_read_b64_tr_b16 a[156:157], v13 offset:0
    ds_read_b64_tr_b16 a[158:159], v13 offset:2048
C_l1:
    s_waitcnt vmcnt(36) lgkmcnt(0)
    v_mfma_f32_16x16x32_bf16 v[112:115], a[0:3], a[144:147], v[112:115]
    s_add_u32 s28, s28, 4096
    s_waitcnt vmcnt(30)
    v_mfma_f32_16x16x32_bf16 v[116:119], a[0:3], a[148:151], v[116:119]
    s_barrier
    ds_read_b64_tr_b16 a[160:161], v10 offset:4096
    v_mfma_f32_16x16x32_bf16 v[120:123], a[0:3], a[152:155], v[120:123]
    ds_read_b64_tr_b16 a[162:163], v10 offset:6144
    ds_read_b64_tr_b16 a[164:165], v11 offset:4096
    v_mfma_f32_16x16x32_bf16 v[124:127], a[0:3], a[156:159], v[124:127]
    buffer_load_dwordx4 a[0:3], v2, s[12:15], s28 offen offset:0
    v_mfma_f32_16x16x32_bf16 v[128:131], a[4:7], a[144:147], v[128:131]
    ds_read_b64_tr_b16 a[166:167], v11 offset:6144
    ds_read_b64_tr_b16 a[168:169], v12 offset:4096
    v_mfma_f32_16x16x32_bf16 v[132:135], a[4:7], a[148:151], v[132:135]
    ds_read_b64_tr_b16 a[170:171], v12 offset:6144
    ds_read_b64_tr_b16 a[172:173], v13 offset:4096
    v_mfma_f32_16x16x32_bf16 v[136:139], a[4:7], a[152:155], v[136:139]
    ds_read_b64_tr_b16 a[174:175], v13 offset:6144
    buffer_load_dwordx4 v2, s[12:15], s20 offen lds
    v_mfma_f32_16x16x32_bf16 v[140:143], a[4:7], a[156:159], v[140:143]
    buffer_load_dwordx4 a[4:7], v2, s[12:15], s28 offen offset:1024
    v_mfma_f32_16x16x32_bf16 v[144:147], a[8:11], a[144:147], v[144:147]
    s_add_u32 m0, m0, 4096
    s_add_u32 s20, s20, 4096
    v_mfma_f32_16x16x32_bf16 v[148:151], a[8:11], a[148:151], v[148:151]
    v_mfma_f32_16x16x32_bf16 v[152:155], a[8:11], a[152:155], v[152:155]
    v_mfma_f32_16x16x32_bf16 v[156:159], a[8:11], a[156:159], v[156:159]
    buffer_load_dwordx4 a[8:11], v2, s[12:15], s28 offen offset:2048
    s_waitcnt vmcnt(37)
    v_mfma_f32_16x16x32_bf16 v[160:163], a[12:15], a[144:147], v[160:163]
    v_mfma_f32_16x16x32_bf16 v[164:167], a[12:15], a[148:151], v[164:167]
    v_mfma_f32_16x16x32_bf16 v[168:171], a[12:15], a[152:155], v[168:171]
    v_mfma_f32_16x16x32_bf16 v[172:175], a[12:15], a[156:159], v[172:175]
    buffer_load_dwordx4 a[12:15], v2, s[12:15], s28 offen offset:3072
    v_mfma_f32_16x16x32_bf16 v[176:179], a[16:19], a[144:147], v[176:179]
    s_add_u32 s28, s28, 4096
    v_mfma_f32_16x16x32_bf16 v[180:183], a[16:19], a[148:151], v[180:183]
    v_mfma_f32_16x16x32_bf16 v[184:187], a[16:19], a[152:155], v[184:187]
    v_mfma_f32_16x16x32_bf16 v[188:191], a[16:19], a[156:159], v[188:191]
    buffer_load_dwordx4 a[16:19], v2, s[12:15], s28 offen offset:0
    v_mfma_f32_16x16x32_bf16 v[32:35], v[40:43], a[144:147], v[32:35]
    v_mfma_f32_16x16x32_bf16 v[36:39], a[144:147], a[144:147], v[36:39]
    v_mfma_f32_16x16x32_bf16 v[192:195], a[20:23], a[144:147], v[192:195]
    v_mfma_f32_16x16x32_bf16 v[196:199], a[20:23], a[148:151], v[196:199]
    v_mfma_f32_16x16x32_bf16 v[200:203], a[20:23], a[152:155], v[200:203]
    v_mfma_f32_16x16x32_bf16 v[204:207], a[20:23], a[156:159], v[204:207]
    buffer_load_dwordx4 a[20:23], v2, s[12:15], s28 offen offset:1024
    s_waitcnt vmcnt(37)
    v_mfma_f32_16x16x32_bf16 v[208:211], a[24:27], a[144:147], v[208:211]
    v_mfma_f32_16x16x32_bf16 v[212:215], a[24:27], a[148:151], v[212:215]
    v_mfma_f32_16x16x32_bf16 v[216:219], a[24:27], a[152:155], v[216:219]
    v_mfma_f32_16x16x32_bf16 v[220:223], a[24:27], a[156:159], v[220:223]
    buffer_load_dwordx4 a[24:27], v2, s[12:15], s28 offen offset:2048
    v_mfma_f32_16x16x32_bf16 v[224:227], a[28:31], a[144:147], v[224:227]
    v_mfma_f32_16x16x32_bf16 v[228:231], a[28:31], a[148:151], v[228:231]
    v_mfma_f32_16x16x32_bf16 v[232:235], a[28:31], a[152:155], v[232:235]
    v_mfma_f32_16x16x32_bf16 v[236:239], a[28:31], a[156:159], v[236:239]
    buffer_load_dwordx4 a[28:31], v2, s[12:15], s28 offen offset:3072
    v_mfma_f32_16x16x32_bf16 v[240:243], a[32:35], a[144:147], v[240:243]
    s_add_u32 s28, s28, 4096
    v_mfma_f32_16x16x32_bf16 v[244:247], a[32:35], a[148:151], v[244:247]
    v_mfma_f32_16x16x32_bf16 v[248:251], a[32:35], a[152:155], v[248:251]
    v_mfma_f32_16x16x32_bf16 v[252:255], a[32:35], a[156:159], v[252:255]
    buffer_load_dwordx4 a[32:35], v2, s[12:15], s28 offen offset:0
    s_waitcnt vmcnt(36) lgkmcnt(0)
    v_mfma_f32_16x16x32_bf16 v[112:115], a[36:39], a[160:163], v[112:115]
    ds_read_b64_tr_b16 a[176:177], v10 offset:8192
    ds_read_b64_tr_b16 a[178:179], v10 offset:10240
    v_mfma_f32_16x16x32_bf16 v[116:119], a[36:39], a[164:167], v[116:119]
    ds_read_b64_tr_b16 a[180:181], v11 offset:8192
    ds_read_b64_tr_b16 a[182:183], v11 offset:10240
    v_mfma_f32_16x16x32_bf16 v[120:123], a[36:39], a[168:171], v[120:123]
    ds_read_b64_tr_b16 a[184:185], v12 offset:8192
    ds_read_b64_tr_b16 a[186:187], v12 offset:10240
    v_mfma_f32_16x16x32_bf16 v[124:127], a[36:39], a[172:175], v[124:127]
    buffer_load_dwordx4 a[36:39], v2, s[12:15], s28 offen offset:1024
    v_mfma_f32_16x16x32_bf16 v[128:131], a[40:43], a[160:163], v[128:131]
    ds_read_b64_tr_b16 a[188:189], v13 offset:8192
    ds_read_b64_tr_b16 a[190:191], v13 offset:10240
    v_mfma_f32_16x16x32_bf16 v[132:135], a[40:43], a[164:167], v[132:135]
    buffer_load_dwordx4 v2, s[12:15], s20 offen lds
    v_mfma_f32_16x16x32_bf16 v[136:139], a[40:43], a[168:171], v[136:139]
    s_add_u32 m0, m0, 4096
    s_add_u32 s20, s20, 4096
    v_mfma_f32_16x16x32_bf16 v[140:143], a[40:43], a[172:175], v[140:143]
    buffer_load_dwordx4 a[40:43], v2, s[12:15], s28 offen offset:2048
    v_mfma_f32_16x16x32_bf16 v[144:147], a[44:47], a[160:163], v[144:147]
    v_mfma_f32_16x16x32_bf16 v[148:151], a[44:47], a[164:167], v[148:151]
    v_mfma_f32_16x16x32_bf16 v[152:155], a[44:47], a[168:171], v[152:155]
    v_mfma_f32_16x16x32_bf16 v[156:159], a[44:47], a[172:175], v[156:159]
    buffer_load_dwordx4 a[44:47], v2, s[12:15], s28 offen offset:3072
    s_waitcnt vmcnt(37)
    v_mfma_f32_16x16x32_bf16 v[160:163], a[48:51], a[160:163], v[160:163]
    s_add_u32 s28, s28, 4096
    v_mfma_f32_16x16x32_bf16 v[164:167], a[48:51], a[164:167], v[164:167]
    v_mfma_f32_16x16x32_bf16 v[168:171], a[48:51], a[168:171], v[168:171]
    v_mfma_f32_16x16x32_bf16 v[172:175], a[48:51], a[172:175], v[172:175]
    buffer_load_dwordx4 a[48:51], v2, s[12:15], s28 offen offset:0
    v_mfma_f32_16x16x32_bf16 v[176:179], a[52:55], a[160:163], v[176:179]
    v_mfma_f32_16x16x32_bf16 v[180:183], a[52:55], a[164:167], v[180:183]
    v_mfma_f32_16x16x32_bf16 v[184:187], a[52:55], a[168:171], v[184:187]
    v_mfma_f32_16x16x32_bf16 v[188:191], a[52:55], a[172:175], v[188:191]
    buffer_load_dwordx4 a[52:55], v2, s[12:15], s28 offen offset:1024
    v_mfma_f32_16x16x32_bf16 v[32:35], v[40:43], a[160:163], v[32:35]
    v_mfma_f32_16x16x32_bf16 v[36:39], a[160:163], a[160:163], v[36:39]
    v_mfma_f32_16x16x32_bf16 v[192:195], a[56:59], a[160:163], v[192:195]
    v_mfma_f32_16x16x32_bf16 v[196:199], a[56:59], a[164:167], v[196:199]
    v_mfma_f32_16x16x32_bf16 v[200:203], a[56:59], a[168:171], v[200:203]
    v_mfma_f32_16x16x32_bf16 v[204:207], a[56:59], a[172:175], v[204:207]
    buffer_load_dwordx4 a[56:59], v2, s[12:15], s28 offen offset:2048
    s_waitcnt vmcnt(37)
    v_mfma_f32_16x16x32_bf16 v[208:211], a[60:63], a[160:163], v[208:211]
    v_mfma_f32_16x16x32_bf16 v[212:215], a[60:63], a[164:167], v[212:215]
    v_mfma_f32_16x16x32_bf16 v[216:219], a[60:63], a[168:171], v[216:219]
    v_mfma_f32_16x16x32_bf16 v[220:223], a[60:63], a[172:175], v[220:223]
    buffer_load_dwordx4 a[60:63], v2, s[12:15], s28 offen offset:3072
    v_mfma_f32_16x16x32_bf16 v[224:227], a[64:67], a[160:163], v[224:227]
    s_add_u32 s28, s28, 4096
    v_mfma_f32_16x16x32_bf16 v[228:231], a[64:67], a[164:167], v[228:231]
    v_mfma_f32_16x16x32_bf16 v[232:235], a[64:67], a[168:171], v[232:235]
    v_mfma_f32_16x16x32_bf16 v[236:239], a[64:67], a[172:175], v[236:239]
    buffer_load_dwordx4 a[64:67], v2, s[12:15], s28 offen offset:0
    v_mfma_f32_16x16x32_bf16 v[240:243], a[68:71], a[160:163], v[240:243]
    v_mfma_f32_16x16x32_bf16 v[244:247], a[68:71], a[164:167], v[244:247]
    v_mfma_f32_16x16x32_bf16 v[248:251], a[68:71], a[168:171], v[248:251]
    v_mfma_f32_16x16x32_bf16 v[252:255], a[68:71], a[172:175], v[252:255]
    buffer_load_dwordx4 a[68:71], v2, s[12:15], s28 offen offset:1024
    s_waitcnt vmcnt(36) lgkmcnt(0)
    v_mfma_f32_16x16x32_bf16 v[112:115], a[72:75], a[176:179], v[112:115]
    s_waitcnt vmcnt(30)
    s_barrier
    v_mfma_f32_16x16x32_bf16 v[116:119], a[72:75], a[180:183], v[116:119]
    ds_read_b64_tr_b16 a[192:193], v10 offset:12288
    ds_read_b64_tr_b16 a[194:195], v10 offset:14336
    v_mfma_f32_16x16x32_bf16 v[120:123], a[72:75], a[184:187], v[120:123]
    ds_read_b64_tr_b16 a[196:197], v11 offset:12288
    ds_read_b64_tr_b16 a[198:199], v11 offset:14336
    v_mfma_f32_16x16x32_bf16 v[124:127], a[72:75], a[188:191], v[124:127]
    buffer_load_dwordx4 a[72:75], v2, s[12:15], s28 offen offset:2048
    v_mfma_f32_16x16x32_bf16 v[128:131], a[76:79], a[176:179], v[128:131]
    ds_read_b64_tr_b16 a[200:201], v12 offset:12288
    ds_read_b64_tr_b16 a[202:203], v12 offset:14336
    v_mfma_f32_16x16x32_bf16 v[132:135], a[76:79], a[180:183], v[132:135]
    ds_read_b64_tr_b16 a[204:205], v13 offset:12288
    ds_read_b64_tr_b16 a[206:207], v13 offset:14336
    v_mfma_f32_16x16x32_bf16 v[136:139], a[76:79], a[184:187], v[136:139]
    buffer_load_dwordx4 v2, s[12:15], s20 offen lds
    v_mfma_f32_16x16x32_bf16 v[140:143], a[76:79], a[188:191], v[140:143]
    buffer_load_dwordx4 a[76:79], v2, s[12:15], s28 offen offset:3072
    v_mfma_f32_16x16x32_bf16 v[144:147], a[80:83], a[176:179], v[144:147]
    s_add_u32 s28, s28, 4096
    s_add_u32 m0, m0, 4096
    v_mfma_f32_16x16x32_bf16 v[148:151], a[80:83], a[180:183], v[148:151]
    s_add_u32 s20, s20, 4096
    v_mfma_f32_16x16x32_bf16 v[152:155], a[80:83], a[184:187], v[152:155]
    v_mfma_f32_16x16x32_bf16 v[156:159], a[80:83], a[188:191], v[156:159]
    buffer_load_dwordx4 a[80:83], v2, s[12:15], s28 offen offset:0
    s_waitcnt vmcnt(37)
    v_mfma_f32_16x16x32_bf16 v[160:163], a[84:87], a[176:179], v[160:163]
    v_mfma_f32_16x16x32_bf16 v[164:167], a[84:87], a[180:183], v[164:167]
    v_mfma_f32_16x16x32_bf16 v[168:171], a[84:87], a[184:187], v[168:171]
    v_mfma_f32_16x16x32_bf16 v[172:175], a[84:87], a[188:191], v[172:175]
    buffer_load_dwordx4 a[84:87], v2, s[12:15], s28 offen offset:1024
    v_mfma_f32_16x16x32_bf16 v[176:179], a[88:91], a[176:179], v[176:179]
    v_mfma_f32_16x16x32_bf16 v[180:183], a[88:91], a[180:183], v[180:183]
    v_mfma_f32_16x16x32_bf16 v[184:187], a[88:91], a[184:187], v[184:187]
    v_mfma_f32_16x16x32_bf16 v[188:191], a[88:91], a[188:191], v[188:191]
    buffer_load_dwordx4 a[88:91], v2, s[12:15], s28 offen offset:2048
    v_mfma_f32_16x16x32_bf16 v[32:35], v[40:43], a[176:179], v[32:35]
    v_mfma_f32_16x16x32_bf16 v[36:39], a[176:179], a[176:179], v[36:39]
    v_mfma_f32_16x16x32_bf16 v[192:195], a[92:95], a[176:179], v[192:195]
    v_mfma_f32_16x16x32_bf16 v[196:199], a[92:95], a[180:183], v[196:199]
    v_mfma_f32_16x16x32_bf16 v[200:203], a[92:95], a[184:187], v[200:203]
    v_mfma_f32_16x16x32_bf16 v[204:207], a[92:95], a[188:191], v[204:207]
    buffer_load_dwordx4 a[92:95], v2, s[12:15], s28 offen offset:3072
    s_waitcnt vmcnt(37)
    v_mfma_f32_16x16x32_bf16 v[208:211], a[96:99], a[176:179], v[208:211]
    s_add_u32 s28, s28, 4096
    v_mfma_f32_16x16x32_bf16 v[212:215], a[96:99], a[180:183], v[212:215]
    v_mfma_f32_16x16x32_bf16 v[216:219], a[96:99], a[184:187], v[216:219]
    v_mfma_f32_16x16x32_bf16 v[220:223], a[96:99], a[188:191], v[220:223]
    buffer_load_dwordx4 a[96:99], v2, s[12:15], s28 offen offset:0
    v_mfma_f32_16x16x32_bf16 v[224:227], a[100:103], a[176:179], v[224:227]
    v_mfma_f32_16x16x32_bf16 v[228:231], a[100:103], a[180:183], v[228:231]
    v_mfma_f32_16x16x32_bf16 v[232:235], a[100:103], a[184:187], v[232:235]
    v_mfma_f32_16x16x32_bf16 v[236:239], a[100:103], a[188:191], v[236:239]
    buffer_load_dwordx4 a[100:103], v2, s[12:15], s28 offen offset:1024
    v_mfma_f32_16x16x32_bf16 v[240:243], a[104:107], a[176:179], v[240:243]
    v_mfma_f32_16x16x32_bf16 v[244:247], a[104:107], a[180:183], v[244:247]
    v_mfma_f32_16x16x32_bf16 v[248:251], a[104:107], a[184:187], v[248:251]
    v_mfma_f32_16x16x32_bf16 v[252:255], a[104:107], a[188:191], v[252:255]
    buffer_load_dwordx4 a[104:107], v2, s[12:15], s28 offen offset:2048
    s_waitcnt vmcnt(36) lgkmcnt(0)
    v_mfma_f32_16x16x32_bf16 v[112:115], a[108:111], a[192:195], v[112:115]
    ds_read_b64_tr_b16 a[144:145], v10 offset:16384
    ds_read_b64_tr_b16 a[146:147], v10 offset:18432
    v_mfma_f32_16x16x32_bf16 v[116:119], a[108:111], a[196:199], v[116:119]
    ds_read_b64_tr_b16 a[148:149], v11 offset:16384
    ds_read_b64_tr_b16 a[150:151], v11 offset:18432
    v_mfma_f32_16x16x32_bf16 v[120:123], a[108:111], a[200:203], v[120:123]
    ds_read_b64_tr_b16 a[152:153], v12 offset:16384
    ds_read_b64_tr_b16 a[154:155], v12 offset:18432
    v_mfma_f32_16x16x32_bf16 v[124:127], a[108:111], a[204:207], v[124:127]
    buffer_load_dwordx4 a[108:111], v2, s[12:15], s28 offen offset:3072
    v_mfma_f32_16x16x32_bf16 v[128:131], a[112:115], a[192:195], v[128:131]
    s_add_u32 s28, s28, 4096
    ds_read_b64_tr_b16 a[156:157], v13 offset:16384
    v_mfma_f32_16x16x32_bf16 v[132:135], a[112:115], a[196:199], v[132:135]
    ds_read_b64_tr_b16 a[158:159], v13 offset:18432
    buffer_load_dwordx4 v2, s[12:15], s20 offen lds
    v_mfma_f32_16x16x32_bf16 v[136:139], a[112:115], a[200:203], v[136:139]
    s_add_u32 m0, m0, 4096
    s_add_u32 s20, s20, 4096
    v_mfma_f32_16x16x32_bf16 v[140:143], a[112:115], a[204:207], v[140:143]
    buffer_load_dwordx4 a[112:115], v2, s[12:15], s28 offen offset:0
    v_mfma_f32_16x16x32_bf16 v[144:147], a[116:119], a[192:195], v[144:147]
    v_add_u32 v10, 0x4000, v10
    v_add_u32 v11, 0x4000, v11
    v_mfma_f32_16x16x32_bf16 v[148:151], a[116:119], a[196:199], v[148:151]
    v_add_u32 v12, 0x4000, v12
    v_add_u32 v13, 0x4000, v13
    v_mfma_f32_16x16x32_bf16 v[152:155], a[116:119], a[200:203], v[152:155]
    v_mfma_f32_16x16x32_bf16 v[156:159], a[116:119], a[204:207], v[156:159]
    buffer_load_dwordx4 a[116:119], v2, s[12:15], s28 offen offset:1024
    s_waitcnt vmcnt(37)
    v_mfma_f32_16x16x32_bf16 v[160:163], a[120:123], a[192:195], v[160:163]
    v_mfma_f32_16x16x32_bf16 v[164:167], a[120:123], a[196:199], v[164:167]
    v_mfma_f32_16x16x32_bf16 v[168:171], a[120:123], a[200:203], v[168:171]
    v_mfma_f32_16x16x32_bf16 v[172:175], a[120:123], a[204:207], v[172:175]
    buffer_load_dwordx4 a[120:123], v2, s[12:15], s28 offen offset:2048
    v_mfma_f32_16x16x32_bf16 v[176:179], a[124:127], a[192:195], v[176:179]
    v_mfma_f32_16x16x32_bf16 v[180:183], a[124:127], a[196:199], v[180:183]
    v_mfma_f32_16x16x32_bf16 v[184:187], a[124:127], a[200:203], v[184:187]
    v_mfma_f32_16x16x32_bf16 v[188:191], a[124:127], a[204:207], v[188:191]
    buffer_load_dwordx4 a[124:127], v2, s[12:15], s28 offen offset:3072
    v_mfma_f32_16x16x32_bf16 v[32:35], v[40:43], a[192:195], v[32:35]
    v_mfma_f32_16x16x32_bf16 v[36:39], a[192:195], a[192:195], v[36:39]
    v_mfma_f32_16x16x32_bf16 v[192:195], a[128:131], a[192:195], v[192:195]
    s_add_u32 s28, s28, 4096
    v_mfma_f32_16x16x32_bf16 v[196:199], a[128:131], a[196:199], v[196:199]
    v_mfma_f32_16x16x32_bf16 v[200:203], a[128:131], a[200:203], v[200:203]
    v_mfma_f32_16x16x32_bf16 v[204:207], a[128:131], a[204:207], v[204:207]
    buffer_load_dwordx4 a[128:131], v2, s[12:15], s28 offen offset:0
    s_waitcnt vmcnt(37)
    v_mfma_f32_16x16x32_bf16 v[208:211], a[132:135], a[192:195], v[208:211]
    v_mfma_f32_16x16x32_bf16 v[212:215], a[132:135], a[196:199], v[212:215]
    v_mfma_f32_16x16x32_bf16 v[216:219], a[132:135], a[200:203], v[216:219]
    v_mfma_f32_16x16x32_bf16 v[220:223], a[132:135], a[204:207], v[220:223]
    buffer_load_dwordx4 a[132:135], v2, s[12:15], s28 offen offset:1024
    v_mfma_f32_16x16x32_bf16 v[224:227], a[136:139], a[192:195], v[224:227]
    v_mfma_f32_16x16x32_bf16 v[228:231], a[136:139], a[196:199], v[228:231]
    v_mfma_f32_16x16x32_bf16 v[232:235], a[136:139], a[200:203], v[232:235]
    v_mfma_f32_16x16x32_bf16 v[236:239], a[136:139], a[204:207], v[236:239]
    buffer_load_dwordx4 a[136:139], v2, s[12:15], s28 offen offset:2048
    v_mfma_f32_16x16x32_bf16 v[240:243], a[140:143], a[192:195], v[240:243]
    v_mfma_f32_16x16x32_bf16 v[244:247], a[140:143], a[196:199], v[244:247]
    v_mfma_f32_16x16x32_bf16 v[248:251], a[140:143], a[200:203], v[248:251]
    v_mfma_f32_16x16x32_bf16 v[252:255], a[140:143], a[204:207], v[252:255]
    buffer_load_dwordx4 a[140:143], v2, s[12:15], s28 offen offset:3072
    s_sub_u32 s37, s37, 1
    s_cmp_lg_u32 s37, 0
    s_cbranch_scc1 C_l1
    s_waitcnt vmcnt(36) lgkmcnt(0)
    v_mfma_f32_16x16x32_bf16 v[112:115], a[0:3], a[144:147], v[112:115]
    s_add_u32 s28, s28, 4096
    s_waitcnt vmcnt(38)
    v_mfma_f32_16x16x32_bf16 v[116:119], a[0:3], a[148:151], v[116:119]
    s_barrier
    ds_read_b64_tr_b16 a[160:161], v10 offset:4096
    v_mfma_f32_16x16x32_bf16 v[120:123], a[0:3], a[152:155], v[120:123]
    ds_read_b64_tr_b16 a[162:163], v10 offset:6144
    ds_read_b64_tr_b16 a[164:165], v11 offset:4096
    v_mfma_f32_16x16x32_bf16 v[124:127], a[0:3], a[156:159], v[124:127]
    buffer_load_dwordx4 a[0:3], v2, s[12:15], s28 offen offset:0
    v_mfma_f32_16x16x32_bf16 v[128:131], a[4:7], a[144:147], v[128:131]
    ds_read_b64_tr_b16 a[166:167], v11 offset:6144
    ds_read_b64_tr_b16 a[168:169], v12 offset:4096
    v_mfma_f32_16x16x32_bf16 v[132:135], a[4:7], a[148:151], v[132:135]
    ds_read_b64_tr_b16 a[170:171], v12 offset:6144
    ds_read_b64_tr_b16 a[172:173], v13 offset:4096
    v_mfma_f32_16x16x32_bf16 v[136:139], a[4:7], a[152:155], v[136:139]
    ds_read_b64_tr_b16 a[174:175], v13 offset:6144
    buffer_load_dwordx4 v[64:67], v2, s[12:15], s23 offen
    v_mfma_f32_16x16x32_bf16 v[140:143], a[4:7], a[156:159], v[140:143]
    buffer_load_dwordx4 a[4:7], v2, s[12:15], s28 offen offset:1024
    v_mfma_f32_16x16x32_bf16 v[144:147], a[8:11], a[144:147], v[144:147]
    buffer_load_dwordx4 v[68:71], v2, s[12:15], s23 offen offset:1024
    v_mfma_f32_16x16x32_bf16 v[148:151], a[8:11], a[148:151], v[148:151]
    buffer_load_dword v72, v2, s[12:15], s23 offen offset:2048
    v_mfma_f32_16x16x32_bf16 v[152:155], a[8:11], a[152:155], v[152:155]
    s_add_u32 s23, s23, 3072
    buffer_load_dwordx4 v[76:79], v2, s[12:15], s23 offen
    v_mfma_f32_16x16x32_bf16 v[156:159], a[8:11], a[156:159], v[156:159]
    buffer_load_dwordx4 a[8:11], v2, s[12:15], s28 offen offset:2048
    s_waitcnt vmcnt(40)
    v_mfma_f32_16x16x32_bf16 v[160:163], a[12:15], a[144:147], v[160:163]
    buffer_load_dwordx4 v[80:83], v2, s[12:15], s23 offen offset:1024
    v_mfma_f32_16x16x32_bf16 v[164:167], a[12:15], a[148:151], v[164:167]
    buffer_load_dword v84, v2, s[12:15], s23 offen offset:2048
    v_mfma_f32_16x16x32_bf16 v[168:171], a[12:15], a[152:155], v[168:171]
    s_add_u32 s23, s23, 3072
    buffer_load_dwordx4 v[88:91], v2, s[12:15], s23 offen
    v_mfma_f32_16x16x32_bf16 v[172:175], a[12:15], a[156:159], v[172:175]
    buffer_load_dwordx4 a[12:15], v2, s[12:15], s28 offen offset:3072
    v_mfma_f32_16x16x32_bf16 v[176:179], a[16:19], a[144:147], v[176:179]
    s_add_u32 s28, s28, 4096
    buffer_load_dwordx4 v[92:95], v2, s[12:15], s23 offen offset:1024
    v_mfma_f32_16x16x32_bf16 v[180:183], a[16:19], a[148:151], v[180:183]
    buffer_load_dword v96, v2, s[12:15], s23 offen offset:2048
    v_mfma_f32_16x16x32_bf16 v[184:187], a[16:19], a[152:155], v[184:187]
    s_add_u32 s23, s23, 3072
    v_mfma_f32_16x16x32_bf16 v[188:191], a[16:19], a[156:159], v[188:191]
    buffer_load_dwordx4 a[16:19], v2, s[12:15], s28 offen offset:0
    v_mfma_f32_16x16x32_bf16 v[32:35], v[40:43], a[144:147], v[32:35]
    v_mfma_f32_16x16x32_bf16 v[36:39], a[144:147], a[144:147], v[36:39]
    v_mfma_f32_16x16x32_bf16 v[192:195], a[20:23], a[144:147], v[192:195]
    v_mfma_f32_16x16x32_bf16 v[196:199], a[20:23], a[148:151], v[196:199]
    v_mfma_f32_16x16x32_bf16 v[200:203], a[20:23], a[152:155], v[200:203]
    v_mfma_f32_16x16x32_bf16 v[204:207], a[20:23], a[156:159], v[204:207]
    buffer_load_dwordx4 a[20:23], v2, s[12:15], s28 offen offset:1024
    s_waitcnt vmcnt(45)
    v_mfma_f32_16x16x32_bf16 v[208:211], a[24:27], a[144:147], v[208:211]
    v_mfma_f32_16x16x32_bf16 v[212:215], a[24:27], a[148:151], v[212:215]
    v_mfma_f32_16x16x32_bf16 v[216:219], a[24:27], a[152:155], v[216:219]
    v_mfma_f32_16x16x32_bf16 v[220:223], a[24:27], a[156:159], v[220:223]
    buffer_load_dwordx4 a[24:27], v2, s[12:15], s28 offen offset:2048
    v_mfma_f32_16x16x32_bf16 v[224:227], a[28:31], a[144:147], v[224:227]
    v_mfma_f32_16x16x32_bf16 v[228:231], a[28:31], a[148:151], v[228:231]
    v_mfma_f32_16x16x32_bf16 v[232:235], a[28:31], a[152:155], v[232:235]
    v_mfma_f32_16x16x32_bf16 v[236:239], a[28:31], a[156:159], v[236:239]
    buffer_load_dwordx4 a[28:31], v2, s[12:15], s28 offen offset:3072
    v_mfma_f32_16x16x32_bf16 v[240:243], a[32:35], a[144:147], v[240:243]
    s_add_u32 s28, s28, 4096
    v_mfma_f32_16x16x32_bf16 v[244:247], a[32:35], a[148:151], v[244:247]
    v_mfma_f32_16x16x32_bf16 v[248:251], a[32:35], a[152:155], v[248:251]
    v_mfma_f32_16x16x32_bf16 v[252:255], a[32:35], a[156:159], v[252:255]
    buffer_load_dwordx4 a[32:35], v2, s[12:15], s28 offen offset:0
    s_waitcnt vmcnt(44) lgkmcnt(0)
    v_mfma_f32_16x16x32_bf16 v[112:115], a[36:39], a[160:163], v[112:115]
    ds_read_b64_tr_b16 a[176:177], v10 offset:8192
    ds_read_b64_tr_b16 a[178:179], v10 offset:10240
    v_mfma_f32_16x16x32_bf16 v[116:119], a[36:39], a[164:167], v[116:119]
    ds_read_b64_tr_b16 a[180:181], v11 offset:8192
    ds_read_b64_tr_b16 a[182:183], v11 offset:10240
    v_mfma_f32_16x16x32_bf16 v[120:123], a[36:39], a[168:171], v[120:123]
    ds_read_b64_tr_b16 a[184:185], v12 offset:8192
    ds_read_b64_tr_b16 a[186:187], v12 offset:10240
    v_mfma_f32_16x16x32_bf16 v[124:127], a[36:39], a[172:175], v[124:127]
    buffer_load_dwordx4 a[36:39], v2, s[12:15], s28 offen offset:1024
    v_mfma_f32_16x16x32_bf16 v[128:131], a[40:43], a[160:163], v[128:131]
    ds_read_b64_tr_b16 a[188:189], v13 offset:8192
    ds_read_b64_tr_b16 a[190:191], v13 offset:10240
    v_mfma_f32_16x16x32_bf16 v[132:135], a[40:43], a[164:167], v[132:135]
    s_lshl_b32 s41, s30, 2
    s_lshl_b32 s42, s18, 10
    v_mfma_f32_16x16x32_bf16 v[136:139], a[40:43], a[168:171], v[136:139]
    s_add_u32 s41, s41, s42
    s_add_u32 s41, s41, 39321600
    v_mfma_f32_16x16x32_bf16 v[140:143], a[40:43], a[172:175], v[140:143]
    buffer_load_dwordx4 a[40:43], v2, s[12:15], s28 offen offset:2048
    v_mfma_f32_16x16x32_bf16 v[144:147], a[44:47], a[160:163], v[144:147]
    s_add_u32 s43, s40, 524288
    s_lshl_b32 s44, s17, 7
    v_mfma_f32_16x16x32_bf16 v[148:151], a[44:47], a[164:167], v[148:151]
    s_add_u32 s44, s44, s41
    s_add_u32 s45, s44, 0x10000
    v_mfma_f32_16x16x32_bf16 v[152:155], a[44:47], a[168:171], v[152:155]
    s_mov_b32 s46, s17
    v_and_b32 v29, 3, v0
    v_mfma_f32_16x16x32_bf16 v[156:159], a[44:47], a[172:175], v[156:159]
    buffer_load_dwordx4 a[44:47], v2, s[12:15], s28 offen offset:3072
    s_waitcnt vmcnt(44)
    v_mfma_f32_16x16x32_bf16 v[160:163], a[48:51], a[160:163], v[160:163]
    s_add_u32 s28, s28, 4096
    v_cmp_eq_u32 s[52:53], 1, v29
    v_mfma_f32_16x16x32_bf16 v[164:167], a[48:51], a[164:167], v[164:167]
    v_cmp_eq_u32 s[54:55], 2, v29
    v_cmp_eq_u32 s[56:57], 3, v29
    v_mfma_f32_16x16x32_bf16 v[168:171], a[48:51], a[168:171], v[168:171]
    v_lshrrev_b32 v29, 2, v5
    v_cmp_eq_u32 s[58:59], v29, v7
    v_mfma_f32_16x16x32_bf16 v[172:175], a[48:51], a[172:175], v[172:175]
    buffer_load_dwordx4 a[48:51], v2, s[12:15], s28 offen offset:0
    v_mfma_f32_16x16x32_bf16 v[176:179], a[52:55], a[160:163], v[176:179]
    s_lshl_b32 s36, s16, 8
    s_add_u32 s36, s36, 147456
    v_mfma_f32_16x16x32_bf16 v[180:183], a[52:55], a[164:167], v[180:183]
    v_add_u32 v26, s36, v26
    v_mfma_f32_16x16x32_bf16 v[184:187], a[52:55], a[168:171], v[184:187]
    v_mfma_f32_16x16x32_bf16 v[188:191], a[52:55], a[172:175], v[188:191]
    buffer_load_dwordx4 a[52:55], v2, s[12:15], s28 offen offset:1024
    v_mfma_f32_16x16x32_bf16 v[32:35], v[40:43], a[160:163], v[32:35]
    v_mfma_f32_16x16x32_bf16 v[36:39], a[160:163], a[160:163], v[36:39]
    v_mfma_f32_16x16x32_bf16 v[192:195], a[56:59], a[160:163], v[192:195]
    v_mfma_f32_16x16x32_bf16 v[196:199], a[56:59], a[164:167], v[196:199]
    v_mfma_f32_16x16x32_bf16 v[200:203], a[56:59], a[168:171], v[200:203]
    v_mfma_f32_16x16x32_bf16 v[204:207], a[56:59], a[172:175], v[204:207]
    buffer_load_dwordx4 a[56:59], v2, s[12:15], s28 offen offset:2048
    s_waitcnt vmcnt(44)
    v_mfma_f32_16x16x32_bf16 v[208:211], a[60:63], a[160:163], v[208:211]
    v_mfma_f32_16x16x32_bf16 v[212:215], a[60:63], a[164:167], v[212:215]
    v_mfma_f32_16x16x32_bf16 v[216:219], a[60:63], a[168:171], v[216:219]
    v_mfma_f32_16x16x32_bf16 v[220:223], a[60:63], a[172:175], v[220:223]
    buffer_load_dwordx4 a[60:63], v2, s[12:15], s28 offen offset:3072
    v_mfma_f32_16x16x32_bf16 v[224:227], a[64:67], a[160:163], v[224:227]
    s_add_u32 s28, s28, 4096
    v_mfma_f32_16x16x32_bf16 v[228:231], a[64:67], a[164:167], v[228:231]
    v_mfma_f32_16x16x32_bf16 v[232:235], a[64:67], a[168:171], v[232:235]
    v_mfma_f32_16x16x32_bf16 v[236:239], a[64:67], a[172:175], v[236:239]
    buffer_load_dwordx4 a[64:67], v2, s[12:15], s28 offen offset:0
    v_mfma_f32_16x16x32_bf16 v[240:243], a[68:71], a[160:163], v[240:243]
    v_mfma_f32_16x16x32_bf16 v[244:247], a[68:71], a[164:167], v[244:247]
    v_mfma_f32_16x16x32_bf16 v[248:251], a[68:71], a[168:171], v[248:251]
    v_mfma_f32_16x16x32_bf16 v[252:255], a[68:71], a[172:175], v[252:255]
    buffer_load_dwordx4 a[68:71], v2, s[12:15], s28 offen offset:1024
    s_waitcnt vmcnt(43) lgkmcnt(0)
    v_mfma_f32_16x16x32_bf16 v[112:115], a[72:75], a[176:179], v[112:115]
    s_waitcnt vmcnt(45)
    s_barrier
    v_mfma_f32_16x16x32_bf16 v[116:119], a[72:75], a[180:183], v[116:119]
    ds_read_b64_tr_b16 a[192:193], v10 offset:12288
    ds_read_b64_tr_b16 a[194:195], v10 offset:14336
    v_mfma_f32_16x16x32_bf16 v[120:123], a[72:75], a[184:187], v[120:123]
    ds_read_b64_tr_b16 a[196:197], v11 offset:12288
    ds_read_b64_tr_b16 a[198:199], v11 offset:14336
    v_mfma_f32_16x16x32_bf16 v[124:127], a[72:75], a[188:191], v[124:127]
    buffer_load_dwordx4 a[72:75], v2, s[12:15], s28 offen offset:2048
    v_mfma_f32_16x16x32_bf16 v[128:131], a[76:79], a[176:179], v[128:131]
    ds_read_b64_tr_b16 a[200:201], v12 offset:12288
    ds_read_b64_tr_b16 a[202:203], v12 offset:14336
    v_mfma_f32_16x16x32_bf16 v[132:135], a[76:79], a[180:183], v[132:135]
    ds_read_b64_tr_b16 a[204:205], v13 offset:12288
    ds_read_b64_tr_b16 a[206:207], v13 offset:14336
    v_mfma_f32_16x16x32_bf16 v[136:139], a[76:79], a[184:187], v[136:139]
    s_add_u32 s31, s17, 5
    s_and_b32 s31, s31, 7
    v_mfma_f32_16x16x32_bf16 v[140:143], a[76:79], a[188:191], v[140:143]
    buffer_load_dwordx4 a[76:79], v2, s[12:15], s28 offen offset:3072
    v_mfma_f32_16x16x32_bf16 v[144:147], a[80:83], a[176:179], v[144:147]
    s_add_u32 s28, s28, 4096
    s_lshl_b32 s31, s31, 16
    v_mfma_f32_16x16x32_bf16 v[148:151], a[80:83], a[180:183], v[148:151]
    s_add_u32 s31, s31, s40
    s_add_u32 s32, s17, 6
    v_mfma_f32_16x16x32_bf16 v[152:155], a[80:83], a[184:187], v[152:155]
    s_and_b32 s32, s32, 7
    s_lshl_b32 s32, s32, 16
    v_mfma_f32_16x16x32_bf16 v[156:159], a[80:83], a[188:191], v[156:159]
    buffer_load_dwordx4 a[80:83], v2, s[12:15], s28 offen offset:0
    s_waitcnt vmcnt(43)
    v_mfma_f32_16x16x32_bf16 v[160:163], a[84:87], a[176:179], v[160:163]
    s_add_u32 s32, s32, s40
    s_add_u32 s33, s17, 7
    v_mfma_f32_16x16x32_bf16 v[164:167], a[84:87], a[180:183], v[164:167]
    s_and_b32 s33, s33, 7
    s_lshl_b32 s33, s33, 16
    v_mfma_f32_16x16x32_bf16 v[168:171], a[84:87], a[184:187], v[168:171]
    s_add_u32 s33, s33, s40
    v_mfma_f32_16x16x32_bf16 v[172:175], a[84:87], a[188:191], v[172:175]
    buffer_load_dwordx4 a[84:87], v2, s[12:15], s28 offen offset:1024
    v_mfma_f32_16x16x32_bf16 v[176:179], a[88:91], a[176:179], v[176:179]
    v_mfma_f32_16x16x32_bf16 v[180:183], a[88:91], a[180:183], v[180:183]
    v_mfma_f32_16x16x32_bf16 v[184:187], a[88:91], a[184:187], v[184:187]
    v_mfma_f32_16x16x32_bf16 v[188:191], a[88:91], a[188:191], v[188:191]
    buffer_load_dwordx4 a[88:91], v2, s[12:15], s28 offen offset:2048
    v_mfma_f32_16x16x32_bf16 v[32:35], v[40:43], a[176:179], v[32:35]
    v_mfma_f32_16x16x32_bf16 v[36:39], a[176:179], a[176:179], v[36:39]
    v_mfma_f32_16x16x32_bf16 v[192:195], a[92:95], a[176:179], v[192:195]
    v_mfma_f32_16x16x32_bf16 v[196:199], a[92:95], a[180:183], v[196:199]
    v_mfma_f32_16x16x32_bf16 v[200:203], a[92:95], a[184:187], v[200:203]
    v_mfma_f32_16x16x32_bf16 v[204:207], a[92:95], a[188:191], v[204:207]
    buffer_load_dwordx4 a[92:95], v2, s[12:15], s28 offen offset:3072
    s_waitcnt vmcnt(43)
    v_mfma_f32_16x16x32_bf16 v[208:211], a[96:99], a[176:179], v[208:211]
    s_add_u32 s28, s28, 4096
    v_mfma_f32_16x16x32_bf16 v[212:215], a[96:99], a[180:183], v[212:215]
    v_mfma_f32_16x16x32_bf16 v[216:219], a[96:99], a[184:187], v[216:219]
    v_mfma_f32_16x16x32_bf16 v[220:223], a[96:99], a[188:191], v[220:223]
    buffer_load_dwordx4 a[96:99], v2, s[12:15], s28 offen offset:0
    v_mfma_f32_16x16x32_bf16 v[224:227], a[100:103], a[176:179], v[224:227]
    v_mfma_f32_16x16x32_bf16 v[228:231], a[100:103], a[180:183], v[228:231]
    v_mfma_f32_16x16x32_bf16 v[232:235], a[100:103], a[184:187], v[232:235]
    v_mfma_f32_16x16x32_bf16 v[236:239], a[100:103], a[188:191], v[236:239]
    buffer_load_dwordx4 a[100:103], v2, s[12:15], s28 offen offset:1024
    v_mfma_f32_16x16x32_bf16 v[240:243], a[104:107], a[176:179], v[240:243]
    v_mfma_f32_16x16x32_bf16 v[244:247], a[104:107], a[180:183], v[244:247]
    v_mfma_f32_16x16x32_bf16 v[248:251], a[104:107], a[184:187], v[248:251]
    v_mfma_f32_16x16x32_bf16 v[252:255], a[104:107], a[188:191], v[252:255]
    buffer_load_dwordx4 a[104:107], v2, s[12:15], s28 offen offset:2048
    s_waitcnt vmcnt(42) lgkmcnt(0)
    v_mfma_f32_16x16x32_bf16 v[112:115], a[108:111], a[192:195], v[112:115]
    ds_read_b64_tr_b16 a[144:145], v10 offset:16384
    ds_read_b64_tr_b16 a[146:147], v10 offset:18432
    v_mfma_f32_16x16x32_bf16 v[116:119], a[108:111], a[196:199], v[116:119]
    ds_read_b64_tr_b16 a[148:149], v11 offset:16384
    ds_read_b64_tr_b16 a[150:151], v11 offset:18432
    v_mfma_f32_16x16x32_bf16 v[120:123], a[108:111], a[200:203], v[120:123]
    ds_read_b64_tr_b16 a[152:153], v12 offset:16384
    ds_read_b64_tr_b16 a[154:155], v12 offset:18432
    v_mfma_f32_16x16x32_bf16 v[124:127], a[108:111], a[204:207], v[124:127]
    buffer_load_dwordx4 a[108:111], v2, s[12:15], s28 offen offset:3072
    v_mfma_f32_16x16x32_bf16 v[128:131], a[112:115], a[192:195], v[128:131]
    s_add_u32 s28, s28, 4096
    ds_read_b64_tr_b16 a[156:157], v13 offset:16384
    v_mfma_f32_16x16x32_bf16 v[132:135], a[112:115], a[196:199], v[132:135]
    ds_read_b64_tr_b16 a[158:159], v13 offset:18432
    s_waitcnt vmcnt(24)
    v_mfma_f32_16x16x32_bf16 v[136:139], a[112:115], a[200:203], v[136:139]
    v_add_f32 v64, v64, v76
    v_add_f32 v65, v65, v77
    v_mfma_f32_16x16x32_bf16 v[140:143], a[112:115], a[204:207], v[140:143]
    buffer_load_dwordx4 a[112:115], v2, s[12:15], s28 offen offset:0
    v_mfma_f32_16x16x32_bf16 v[144:147], a[116:119], a[192:195], v[144:147]
    v_add_f32 v66, v66, v78
    v_add_f32 v67, v67, v79
    v_mfma_f32_16x16x32_bf16 v[148:151], a[116:119], a[196:199], v[148:151]
    v_add_f32 v68, v68, v80
    v_add_f32 v69, v69, v81
    v_mfma_f32_16x16x32_bf16 v[152:155], a[116:119], a[200:203], v[152:155]
    v_add_f32 v70, v70, v82
    v_add_f32 v71, v71, v83
    v_mfma_f32_16x16x32_bf16 v[156:159], a[116:119], a[204:207], v[156:159]
    buffer_load_dwordx4 a[116:119], v2, s[12:15], s28 offen offset:1024
    s_waitcnt vmcnt(42)
    v_mfma_f32_16x16x32_bf16 v[160:163], a[120:123], a[192:195], v[160:163]
    v_add_f32 v72, v72, v84
    v_add_f32 v64, v64, v88
    v_mfma_f32_16x16x32_bf16 v[164:167], a[120:123], a[196:199], v[164:167]
    v_add_f32 v65, v65, v89
    v_add_f32 v66, v66, v90
    v_mfma_f32_16x16x32_bf16 v[168:171], a[120:123], a[200:203], v[168:171]
    v_add_f32 v67, v67, v91
    v_add_f32 v68, v68, v92
    v_mfma_f32_16x16x32_bf16 v[172:175], a[120:123], a[204:207], v[172:175]
    buffer_load_dwordx4 a[120:123], v2, s[12:15], s28 offen offset:2048
    v_mfma_f32_16x16x32_bf16 v[176:179], a[124:127], a[192:195], v[176:179]
    v_add_f32 v69, v69, v93
    v_add_f32 v70, v70, v94
    v_mfma_f32_16x16x32_bf16 v[180:183], a[124:127], a[196:199], v[180:183]
    v_add_f32 v71, v71, v95
    v_add_f32 v72, v72, v96
    v_mfma_f32_16x16x32_bf16 v[184:187], a[124:127], a[200:203], v[184:187]
    v_mfma_f32_16x16x32_bf16 v[188:191], a[124:127], a[204:207], v[188:191]
    buffer_load_dwordx4 a[124:127], v2, s[12:15], s28 offen offset:3072
    v_mfma_f32_16x16x32_bf16 v[32:35], v[40:43], a[192:195], v[32:35]
    v_mfma_f32_16x16x32_bf16 v[36:39], a[192:195], a[192:195], v[36:39]
    v_mfma_f32_16x16x32_bf16 v[192:195], a[128:131], a[192:195], v[192:195]
    s_add_u32 s28, s28, 4096
    v_mfma_f32_16x16x32_bf16 v[196:199], a[128:131], a[196:199], v[196:199]
    v_mfma_f32_16x16x32_bf16 v[200:203], a[128:131], a[200:203], v[200:203]
    v_mfma_f32_16x16x32_bf16 v[204:207], a[128:131], a[204:207], v[204:207]
    buffer_load_dwordx4 a[128:131], v2, s[12:15], s28 offen offset:0
    s_waitcnt vmcnt(42)
    v_mfma_f32_16x16x32_bf16 v[208:211], a[132:135], a[192:195], v[208:211]
    v_mfma_f32_16x16x32_bf16 v[212:215], a[132:135], a[196:199], v[212:215]
    v_mfma_f32_16x16x32_bf16 v[216:219], a[132:135], a[200:203], v[216:219]
    v_mfma_f32_16x16x32_bf16 v[220:223], a[132:135], a[204:207], v[220:223]
    buffer_load_dwordx4 a[132:135], v2, s[12:15], s28 offen offset:1024
    v_mfma_f32_16x16x32_bf16 v[224:227], a[136:139], a[192:195], v[224:227]
    v_mfma_f32_16x16x32_bf16 v[228:231], a[136:139], a[196:199], v[228:231]
    v_mfma_f32_16x16x32_bf16 v[232:235], a[136:139], a[200:203], v[232:235]
    v_mfma_f32_16x16x32_bf16 v[236:239], a[136:139], a[204:207], v[236:239]
    buffer_load_dwordx4 a[136:139], v2, s[12:15], s28 offen offset:2048
    v_mfma_f32_16x16x32_bf16 v[240:243], a[140:143], a[192:195], v[240:243]
    v_mfma_f32_16x16x32_bf16 v[244:247], a[140:143], a[196:199], v[244:247]
    v_mfma_f32_16x16x32_bf16 v[248:251], a[140:143], a[200:203], v[248:251]
    v_mfma_f32_16x16x32_bf16 v[252:255], a[140:143], a[204:207], v[252:255]
    buffer_load_dwordx4 a[140:143], v2, s[12:15], s28 offen offset:3072
    s_waitcnt vmcnt(38) lgkmcnt(0)
    v_mfma_f32_16x16x32_bf16 v[112:115], a[0:3], a[144:147], v[112:115]
    s_add_u32 s28, s28, 4096
    s_waitcnt vmcnt(53)
    v_mfma_f32_16x16x32_bf16 v[116:119], a[0:3], a[148:151], v[116:119]
    s_barrier
    ds_read_b64_tr_b16 a[160:161], v10 offset:20480
    v_mfma_f32_16x16x32_bf16 v[120:123], a[0:3], a[152:155], v[120:123]
    ds_read_b64_tr_b16 a[162:163], v10 offset:22528
    ds_read_b64_tr_b16 a[164:165], v11 offset:20480
    v_mfma_f32_16x16x32_bf16 v[124:127], a[0:3], a[156:159], v[124:127]
    buffer_load_dwordx4 a[0:3], v2, s[12:15], s28 offen offset:0
    v_mfma_f32_16x16x32_bf16 v[128:131], a[4:7], a[144:147], v[128:131]
    ds_read_b64_tr_b16 a[166:167], v11 offset:22528
    ds_read_b64_tr_b16 a[168:169], v12 offset:20480
    v_mfma_f32_16x16x32_bf16 v[132:135], a[4:7], a[148:151], v[132:135]
    ds_read_b64_tr_b16 a[170:171], v12 offset:22528
    ds_read_b64_tr_b16 a[172:173], v13 offset:20480
    v_mfma_f32_16x16x32_bf16 v[136:139], a[4:7], a[152:155], v[136:139]
    ds_read_b64_tr_b16 a[174:175], v13 offset:22528
    v_cvt_pk_bf16_f32 v94, v64, v64
    v_mfma_f32_16x16x32_bf16 v[140:143], a[4:7], a[156:159], v[140:143]
    buffer_load_dwordx4 a[4:7], v2, s[12:15], s28 offen offset:1024
    v_mfma_f32_16x16x32_bf16 v[144:147], a[8:11], a[144:147], v[144:147]
    v_and_b32 v24, 0xffff0000, v94
    v_sub_f32 v24, v64, v24
    v_mfma_f32_16x16x32_bf16 v[148:151], a[8:11], a[148:151], v[148:151]
    v_cvt_pk_bf16_f32 v95, v24, 0
    v_cvt_pk_bf16_f32 v96, v65, v65
    v_mfma_f32_16x16x32_bf16 v[152:155], a[8:11], a[152:155], v[152:155]
    v_and_b32 v25, 0xffff0000, v96
    v_sub_f32 v25, v65, v25
    v_mfma_f32_16x16x32_bf16 v[156:159], a[8:11], a[156:159], v[156:159]
    buffer_load_dwordx4 a[8:11], v2, s[12:15], s28 offen offset:2048
    s_waitcnt vmcnt(33)
    v_mfma_f32_16x16x32_bf16 v[160:163], a[12:15], a[144:147], v[160:163]
    v_cvt_pk_bf16_f32 v97, v25, 0
    v_cvt_pk_bf16_f32 v98, v66, v66
    v_mfma_f32_16x16x32_bf16 v[164:167], a[12:15], a[148:151], v[164:167]
    v_and_b32 v24, 0xffff0000, v98
    v_sub_f32 v24, v66, v24
    v_mfma_f32_16x16x32_bf16 v[168:171], a[12:15], a[152:155], v[168:171]
    v_cvt_pk_bf16_f32 v99, v24, 0
    v_cvt_pk_bf16_f32 v100, v67, v67
    v_mfma_f32_16x16x32_bf16 v[172:175], a[12:15], a[156:159], v[172:175]
    buffer_load_dwordx4 a[12:15], v2, s[12:15], s28 offen offset:3072
    v_mfma_f32_16x16x32_bf16 v[176:179], a[16:19], a[144:147], v[176:179]
    s_add_u32 s28, s28, 4096
    v_and_b32 v25, 0xffff0000, v100
    v_mfma_f32_16x16x32_bf16 v[180:183], a[16:19], a[148:151], v[180:183]
    v_sub_f32 v25, v67, v25
    v_cvt_pk_bf16_f32 v101, v25, 0
    v_mfma_f32_16x16x32_bf16 v[184:187], a[16:19], a[152:155], v[184:187]
    v_cvt_pk_bf16_f32 v102, v68, v68
    v_and_b32 v24, 0xffff0000, v102
    v_mfma_f32_16x16x32_bf16 v[188:191], a[16:19], a[156:159], v[188:191]
    buffer_load_dwordx4 a[16:19], v2, s[12:15], s28 offen offset:0
    v_mfma_f32_16x16x32_bf16 v[32:35], v[40:43], a[144:147], v[32:35]
    v_sub_f32 v24, v68, v24
    v_cvt_pk_bf16_f32 v103, v24, 0
    v_mfma_f32_16x16x32_bf16 v[36:39], a[144:147], a[144:147], v[36:39]
    v_cvt_pk_bf16_f32 v104, v69, v69
    v_mfma_f32_16x16x32_bf16 v[192:195], a[20:23], a[144:147], v[192:195]
    v_and_b32 v25, 0xffff0000, v104
    v_sub_f32 v25, v69, v25
    v_mfma_f32_16x16x32_bf16 v[196:199], a[20:23], a[148:151], v[196:199]
    v_cvt_pk_bf16_f32 v105, v25, 0
    v_cvt_pk_bf16_f32 v106, v70, v70
    v_mfma_f32_16x16x32_bf16 v[200:203], a[20:23], a[152:155], v[200:203]
    v_and_b32 v24, 0xffff0000, v106
    v_sub_f32 v24, v70, v24
    v_mfma_f32_16x16x32_bf16 v[204:207], a[20:23], a[156:159], v[204:207]
    buffer_load_dwordx4 a[20:23], v2, s[12:15], s28 offen offset:1024
    s_waitcnt vmcnt(33)
    v_mfma_f32_16x16x32_bf16 v[208:211], a[24:27], a[144:147], v[208:211]
    v_cvt_pk_bf16_f32 v107, v24, 0
    v_cvt_pk_bf16_f32 v108, v71, v71
    v_mfma_f32_16x16x32_bf16 v[212:215], a[24:27], a[148:151], v[212:215]
    v_and_b32 v25, 0xffff0000, v108
    v_sub_f32 v25, v71, v25
    v_mfma_f32_16x16x32_bf16 v[216:219], a[24:27], a[152:155], v[216:219]
    v_cvt_pk_bf16_f32 v109, v25, 0
    v_cvt_pk_bf16_f32 v110, v72, v72
    v_mfma_f32_16x16x32_bf16 v[220:223], a[24:27], a[156:159], v[220:223]
    buffer_load_dwordx4 a[24:27], v2, s[12:15], s28 offen offset:2048
    v_mfma_f32_16x16x32_bf16 v[224:227], a[28:31], a[144:147], v[224:227]
    v_and_b32 v24, 0xffff0000, v110
    v_sub_f32 v24, v72, v24
    v_mfma_f32_16x16x32_bf16 v[228:231], a[28:31], a[148:151], v[228:231]
    v_cvt_pk_bf16_f32 v111, v24, 0
    v_mov_b32 v76, -1
    v_mfma_f32_16x16x32_bf16 v[232:235], a[28:31], a[152:155], v[232:235]
    v_mov_b32 v77, -1
    v_mov_b32 v78, -1
    v_mfma_f32_16x16x32_bf16 v[236:239], a[28:31], a[156:159], v[236:239]
    buffer_load_dwordx4 a[28:31], v2, s[12:15], s28 offen offset:3072
    s_waitcnt lgkmcnt(0)
    v_mfma_f32_16x16x32_bf16 v[240:243], a[32:35], a[144:147], v[240:243]
    s_add_u32 s28, s28, 4096
    v_mov_b32 v79, -1
    v_mfma_f32_16x16x32_bf16 v[244:247], a[32:35], a[148:151], v[244:247]
    v_mfma_f32_16x16x32_bf16 v[248:251], a[32:35], a[152:155], v[248:251]
    v_mfma_f32_16x16x32_bf16 v[252:255], a[32:35], a[156:159], v[252:255]
    buffer_load_dwordx4 a[32:35], v2, s[12:15], s28 offen offset:0
    v_mfma_f32_16x16x32_bf16 v[32:35], v[40:43], a[160:163], v[32:35]
    v_mfma_f32_16x16x32_bf16 v[36:39], a[160:163], a[160:163], v[36:39]
    s_waitcnt vmcnt(33)
    v_mfma_f32_16x16x32_bf16 v[112:115], a[36:39], a[160:163], v[112:115]
    v_mfma_f32_16x16x32_bf16 v[116:119], a[36:39], a[164:167], v[116:119]
    v_mfma_f32_16x16x32_bf16 v[120:123], a[36:39], a[168:171], v[120:123]
    v_mfma_f32_16x16x32_bf16 v[124:127], a[36:39], a[172:175], v[124:127]
    buffer_load_dwordx4 a[36:39], v2, s[12:15], s28 offen offset:1024
    v_mfma_f32_16x16x32_bf16 v[128:131], a[40:43], a[160:163], v[128:131]
    v_cndmask_b32 v36, v36, v37, s[52:53]
    v_cndmask_b32 v36, v36, v38, s[54:55]
    v_mfma_f32_16x16x32_bf16 v[132:135], a[40:43], a[164:167], v[132:135]
    v_cndmask_b32 v36, v36, v39, s[56:57]
    v_mul_f32 v28, 0xbae38e39, v32
    v_mfma_f32_16x16x32_bf16 v[136:139], a[40:43], a[168:171], v[136:139]
    v_mul_f32 v36, 0x3ae38e39, v36
    v_fma_f32 v36, -v28, v28, v36
    v_mfma_f32_16x16x32_bf16 v[140:143], a[40:43], a[172:175], v[140:143]
    buffer_load_dwordx4 a[40:43], v2, s[12:15], s28 offen offset:2048
    v_mfma_f32_16x16x32_bf16 v[144:147], a[44:47], a[160:163], v[144:147]
    v_max_f32 v36, 0, v36
    v_add_f32 v36, 0x3727c5ac, v36
    v_mfma_f32_16x16x32_bf16 v[148:151], a[44:47], a[164:167], v[148:151]
    v_rsq_f32 v30, v36
    v_sqrt_f32 v29, v36
    v_mfma_f32_16x16x32_bf16 v[152:155], a[44:47], a[168:171], v[152:155]
    s_mov_b64 exec, s[58:59]
    ds_write_b128 v26, v[28:31]
    s_mov_b64 exec, -1
    v_mfma_f32_16x16x32_bf16 v[156:159], a[44:47], a[172:175], v[156:159]
    buffer_load_dwordx4 a[44:47], v2, s[12:15], s28 offen offset:3072
    s_waitcnt vmcnt(33)
    v_mfma_f32_16x16x32_bf16 v[160:163], a[48:51], a[160:163], v[160:163]
    s_add_u32 s28, s28, 4096
    v_mfma_f32_16x16x32_bf16 v[164:167], a[48:51], a[164:167], v[164:167]
    v_mfma_f32_16x16x32_bf16 v[168:171], a[48:51], a[168:171], v[168:171]
    v_mfma_f32_16x16x32_bf16 v[172:175], a[48:51], a[172:175], v[172:175]
    buffer_load_dwordx4 a[48:51], v2, s[12:15], s28 offen offset:0
    v_mfma_f32_16x16x32_bf16 v[176:179], a[52:55], a[160:163], v[176:179]
    s_waitcnt lgkmcnt(0)
    s_barrier
    v_mfma_f32_16x16x32_bf16 v[180:183], a[52:55], a[164:167], v[180:183]
    ds_read_b32 v24, v18
    ds_read_b32 v25, v19
    v_mfma_f32_16x16x32_bf16 v[184:187], a[52:55], a[168:171], v[184:187]
    ds_read_b32 v26, v20
    ds_read_b32 v27, v21
    v_mfma_f32_16x16x32_bf16 v[188:191], a[52:55], a[172:175], v[188:191]
    buffer_load_dwordx4 a[52:55], v2, s[12:15], s28 offen offset:1024
    v_mfma_f32_16x16x32_bf16 v[192:195], a[56:59], a[160:163], v[192:195]
    v_mfma_f32_16x16x32_bf16 v[196:199], a[56:59], a[164:167], v[196:199]
    v_mfma_f32_16x16x32_bf16 v[200:203], a[56:59], a[168:171], v[200:203]
    v_mfma_f32_16x16x32_bf16 v[204:207], a[56:59], a[172:175], v[204:207]
    buffer_load_dwordx4 a[56:59], v2, s[12:15], s28 offen offset:2048
    s_waitcnt vmcnt(33)
    v_mfma_f32_16x16x32_bf16 v[208:211], a[60:63], a[160:163], v[208:211]
    s_waitcnt lgkmcnt(0)
    v_cvt_pk_bf16_f32 v45, v24, 0
    v_mfma_f32_16x16x32_bf16 v[212:215], a[60:63], a[164:167], v[212:215]
    v_cvt_pk_bf16_f32 v47, v25, 0
    v_cvt_pk_bf16_f32 v49, v26, 0
    v_mfma_f32_16x16x32_bf16 v[216:219], a[60:63], a[168:171], v[216:219]
    v_cvt_pk_bf16_f32 v51, v27, 0
    v_lshlrev_b32 v44, 16, v45
    v_mfma_f32_16x16x32_bf16 v[220:223], a[60:63], a[172:175], v[220:223]
    buffer_load_dwordx4 a[60:63], v2, s[12:15], s28 offen offset:3072
    v_mfma_f32_16x16x32_bf16 v[224:227], a[64:67], a[160:163], v[224:227]
    s_add_u32 s28, s28, 4096
    v_lshlrev_b32 v46, 16, v47
    v_mfma_f32_16x16x32_bf16 v[228:231], a[64:67], a[164:167], v[228:231]
    v_lshlrev_b32 v48, 16, v49
    v_lshlrev_b32 v50, 16, v51
    v_mfma_f32_16x16x32_bf16 v[232:235], a[64:67], a[168:171], v[232:235]
    v_sub_f32 v44, v24, v44
    v_sub_f32 v46, v25, v46
    v_mfma_f32_16x16x32_bf16 v[236:239], a[64:67], a[172:175], v[236:239]
    buffer_load_dwordx4 a[64:67], v2, s[12:15], s28 offen offset:0
    v_mfma_f32_16x16x32_bf16 v[240:243], a[68:71], a[160:163], v[240:243]
    v_sub_f32 v48, v26, v48
    v_sub_f32 v50, v27, v50
    v_mfma_f32_16x16x32_bf16 v[244:247], a[68:71], a[164:167], v[244:247]
    v_cvt_pk_bf16_f32 v44, v24, v44
    v_cvt_pk_bf16_f32 v46, v25, v46
    v_mfma_f32_16x16x32_bf16 v[248:251], a[68:71], a[168:171], v[248:251]
    v_cvt_pk_bf16_f32 v48, v26, v48
    v_cvt_pk_bf16_f32 v50, v27, v50
    v_mfma_f32_16x16x32_bf16 v[252:255], a[68:71], a[172:175], v[252:255]
    buffer_load_dwordx4 a[68:71], v2, s[12:15], s28 offen offset:1024
    s_nop 1
    v_mfma_f32_16x16x16_bf16 v[112:115], v[94:95], v[44:45], v[112:115]
    buffer_store_dwordx4 v[76:79], v2, s[12:15], s31 offen offset:0 sc1
    v_mfma_f32_16x16x16_bf16 v[116:119], v[94:95], v[46:47], v[116:119]
    buffer_store_dwordx4 v[76:79], v2, s[12:15], s31 offen offset:1024 sc1
    v_mfma_f32_16x16x16_bf16 v[120:123], v[94:95], v[48:49], v[120:123]
    buffer_store_dwordx4 v[76:79], v2, s[12:15], s32 offen offset:0 sc1
    v_mfma_f32_16x16x16_bf16 v[124:127], v[94:95], v[50:51], v[124:127]
    buffer_store_dwordx4 v[76:79], v2, s[12:15], s32 offen offset:1024 sc1
    v_mfma_f32_16x16x16_bf16 v[128:131], v[96:97], v[44:45], v[128:131]
    buffer_store_dwordx4 v[76:79], v2, s[12:15], s33 offen offset:0 sc1
    v_mfma_f32_16x16x16_bf16 v[132:135], v[96:97], v[46:47], v[132:135]
    buffer_store_dwordx4 v[76:79], v2, s[12:15], s33 offen offset:1024 sc1
    v_mfma_f32_16x16x16_bf16 v[136:139], v[96:97], v[48:49], v[136:139]
    v_cvt_pk_bf16_f32 v112, v112, v113
    v_cvt_pk_bf16_f32 v113, v114, v115
    v_pk_max_i16 v112, v112, 0
    v_pk_max_i16 v113, v113, 0
    v_mfma_f32_16x16x16_bf16 v[140:143], v[96:97], v[50:51], v[140:143]
    ds_write_b64 v14, v[112:113] offset:0
    v_cvt_pk_bf16_f32 v116, v116, v117
    v_cvt_pk_bf16_f32 v117, v118, v119
    v_mfma_f32_16x16x16_bf16 v[144:147], v[98:99], v[44:45], v[144:147]
    v_pk_max_i16 v116, v116, 0
    v_pk_max_i16 v117, v117, 0
    ds_write_b64 v15, v[116:117] offset:0
    v_mfma_f32_16x16x16_bf16 v[148:151], v[98:99], v[46:47], v[148:151]
    v_cvt_pk_bf16_f32 v120, v120, v121
    v_cvt_pk_bf16_f32 v121, v122, v123
    v_pk_max_i16 v120, v120, 0
    v_pk_max_i16 v121, v121, 0
    v_mfma_f32_16x16x16_bf16 v[152:155], v[98:99], v[48:49], v[152:155]
    ds_write_b64 v16, v[120:121] offset:0
    v_cvt_pk_bf16_f32 v124, v124, v125
    v_cvt_pk_bf16_f32 v125, v126, v127
    v_mfma_f32_16x16x16_bf16 v[156:159], v[98:99], v[50:51], v[156:159]
    v_pk_max_i16 v124, v124, 0
    v_pk_max_i16 v125, v125, 0
    ds_write_b64 v17, v[124:125] offset:0
    v_mfma_f32_16x16x16_bf16 v[160:163], v[100:101], v[44:45], v[160:163]
    v_cvt_pk_bf16_f32 v128, v128, v129
    v_cvt_pk_bf16_f32 v129, v130, v131
    v_pk_max_i16 v128, v128, 0
    v_pk_max_i16 v129, v129, 0
    v_mfma_f32_16x16x16_bf16 v[164:167], v[100:101], v[46:47], v[164:167]
    ds_write_b64 v14, v[128:129] offset:8192
    v_cvt_pk_bf16_f32 v132, v132, v133
    v_cvt_pk_bf16_f32 v133, v134, v135
    v_mfma_f32_16x16x16_bf16 v[168:171], v[100:101], v[48:49], v[168:171]
    v_pk_max_i16 v132, v132, 0
    v_pk_max_i16 v133, v133, 0
    ds_write_b64 v15, v[132:133] offset:8192
    v_mfma_f32_16x16x16_bf16 v[172:175], v[100:101], v[50:51], v[172:175]
    v_cvt_pk_bf16_f32 v136, v136, v137
    v_cvt_pk_bf16_f32 v137, v138, v139
    v_pk_max_i16 v136, v136, 0
    v_pk_max_i16 v137, v137, 0
    v_mfma_f32_16x16x16_bf16 v[176:179], v[102:103], v[44:45], v[176:179]
    ds_write_b64 v16, v[136:137] offset:8192
    v_cvt_pk_bf16_f32 v140, v140, v141
    v_cvt_pk_bf16_f32 v141, v142, v143
    v_mfma_f32_16x16x16_bf16 v[180:183], v[102:103], v[46:47], v[180:183]
    v_pk_max_i16 v140, v140, 0
    v_pk_max_i16 v141, v141, 0
    ds_write_b64 v17, v[140:141] offset:8192
    v_mfma_f32_16x16x16_bf16 v[184:187], v[102:103], v[48:49], v[184:187]
    v_cvt_pk_bf16_f32 v144, v144, v145
    v_cvt_pk_bf16_f32 v145, v146, v147
    v_pk_max_i16 v144, v144, 0
    v_pk_max_i16 v145, v145, 0
    v_mfma_f32_16x16x16_bf16 v[188:191], v[102:103], v[50:51], v[188:191]
    ds_write_b64 v14, v[144:145] offset:16384
    v_cvt_pk_bf16_f32 v148, v148, v149
    v_cvt_pk_bf16_f32 v149, v150, v151
    v_mfma_f32_16x16x16_bf16 v[192:195], v[104:105], v[44:45], v[192:195]
    v_pk_max_i16 v148, v148, 0
    v_pk_max_i16 v149, v149, 0
    ds_write_b64 v15, v[148:149] offset:16384
    v_mfma_f32_16x16x16_bf16 v[196:199], v[104:105], v[46:47], v[196:199]
    v_cvt_pk_bf16_f32 v152, v152, v153
    v_cvt_pk_bf16_f32 v153, v154, v155
    v_pk_max_i16 v152, v152, 0
    v_pk_max_i16 v153, v153, 0
    v_mfma_f32_16x16x16_bf16 v[200:203], v[104:105], v[48:49], v[200:203]
    ds_write_b64 v16, v[152:153] offset:16384
    v_cvt_pk_bf16_f32 v156, v156, v157
    v_cvt_pk_bf16_f32 v157, v158, v159
    v_mfma_f32_16x16x16_bf16 v[204:207], v[104:105], v[50:51], v[204:207]
    v_pk_max_i16 v156, v156, 0
    v_pk_max_i16 v157, v157, 0
    ds_write_b64 v17, v[156:157] offset:16384
    v_mfma_f32_16x16x16_bf16 v[208:211], v[106:107], v[44:45], v[208:211]
    v_cvt_pk_bf16_f32 v160, v160, v161
    v_cvt_pk_bf16_f32 v161, v162, v163
    v_pk_max_i16 v160, v160, 0
    v_pk_max_i16 v161, v161, 0
    v_mfma_f32_16x16x16_bf16 v[212:215], v[106:107], v[46:47], v[212:215]
    ds_write_b64 v14, v[160:161] offset:24576
    v_cvt_pk_bf16_f32 v164, v164, v165
    v_cvt_pk_bf16_f32 v165, v166, v167
    v_mfma_f32_16x16x16_bf16 v[216:219], v[106:107], v[48:49], v[216:219]
    v_pk_max_i16 v164, v164, 0
    v_pk_max_i16 v165, v165, 0
    ds_write_b64 v15, v[164:165] offset:24576
    v_mfma_f32_16x16x16_bf16 v[220:223], v[106:107], v[50:51], v[220:223]
    v_cvt_pk_bf16_f32 v168, v168, v169
    v_cvt_pk_bf16_f32 v169, v170, v171
    v_pk_max_i16 v168, v168, 0
    v_pk_max_i16 v169, v169, 0
    v_mfma_f32_16x16x16_bf16 v[224:227], v[108:109], v[44:45], v[224:227]
    ds_write_b64 v16, v[168:169] offset:24576
    v_cvt_pk_bf16_f32 v172, v172, v173
    v_cvt_pk_bf16_f32 v173, v174, v175
    v_mfma_f32_16x16x16_bf16 v[228:231], v[108:109], v[46:47], v[228:231]
    v_pk_max_i16 v172, v172, 0
    v_pk_max_i16 v173, v173, 0
    ds_write_b64 v17, v[172:173] offset:24576
    v_mfma_f32_16x16x16_bf16 v[232:235], v[108:109], v[48:49], v[232:235]
    v_cvt_pk_bf16_f32 v176, v176, v177
    v_cvt_pk_bf16_f32 v177, v178, v179
    v_pk_max_i16 v176, v176, 0
    v_pk_max_i16 v177, v177, 0
    v_mfma_f32_16x16x16_bf16 v[236:239], v[108:109], v[50:51], v[236:239]
    ds_write_b64 v14, v[176:177] offset:32768
    v_cvt_pk_bf16_f32 v180, v180, v181
    v_cvt_pk_bf16_f32 v181, v182, v183
    v_mfma_f32_16x16x16_bf16 v[240:243], v[110:111], v[44:45], v[240:243]
    v_pk_max_i16 v180, v180, 0
    v_pk_max_i16 v181, v181, 0
    ds_write_b64 v15, v[180:181] offset:32768
    v_mfma_f32_16x16x16_bf16 v[244:247], v[110:111], v[46:47], v[244:247]
    v_cvt_pk_bf16_f32 v184, v184, v185
    v_cvt_pk_bf16_f32 v185, v186, v187
    v_pk_max_i16 v184, v184, 0
    v_pk_max_i16 v185, v185, 0
    v_mfma_f32_16x16x16_bf16 v[248:251], v[110:111], v[48:49], v[248:251]
    ds_write_b64 v16, v[184:185] offset:32768
    v_cvt_pk_bf16_f32 v188, v188, v189
    v_cvt_pk_bf16_f32 v189, v190, v191
    v_mfma_f32_16x16x16_bf16 v[252:255], v[110:111], v[50:51], v[252:255]
    v_pk_max_i16 v188, v188, 0
    v_pk_max_i16 v189, v189, 0
    ds_write_b64 v17, v[188:189] offset:32768
    s_waitcnt lgkmcnt(0)
    s_barrier
    ds_read_b128 a[144:147], v23 offset:0
    ds_read_b128 a[148:151], v23 offset:1024
    ds_read_b128 a[152:155], v23 offset:2048
    ds_read_b128 a[156:159], v23 offset:3072
    ds_read_b128 a[160:163], v23 offset:4096
    ds_read_b128 a[164:167], v23 offset:5120
    ds_read_b128 a[168:171], v23 offset:6144
    ds_read_b128 a[172:175], v23 offset:7168
    v_cvt_pk_bf16_f32 v192, v192, v193
    v_cvt_pk_bf16_f32 v193, v194, v195
    v_pk_max_i16 v192, v192, 0
    v_pk_max_i16 v193, v193, 0
    ds_write_b64 v14, v[192:193] offset:40960
    v_cvt_pk_bf16_f32 v196, v196, v197
    v_cvt_pk_bf16_f32 v197, v198, v199
    v_pk_max_i16 v196, v196, 0
    v_pk_max_i16 v197, v197, 0
    ds_write_b64 v15, v[196:197] offset:40960
    v_cvt_pk_bf16_f32 v200, v200, v201
    v_cvt_pk_bf16_f32 v201, v202, v203
    v_pk_max_i16 v200, v200, 0
    v_pk_max_i16 v201, v201, 0
    ds_write_b64 v16, v[200:201] offset:40960
    v_cvt_pk_bf16_f32 v204, v204, v205
    v_cvt_pk_bf16_f32 v205, v206, v207
    v_pk_max_i16 v204, v204, 0
    v_pk_max_i16 v205, v205, 0
    ds_write_b64 v17, v[204:205] offset:40960
    s_waitcnt vmcnt(40) lgkmcnt(8)
    v_mfma_f32_16x16x32_bf16 v[48:51], a[72:75], a[144:147], 0
    ds_read_b128 a[176:179], v23 offset:8192
    ds_read_b128 a[180:183], v23 offset:9216
    ds_read_b128 a[184:187], v23 offset:10240
    ds_read_b128 a[188:191], v23 offset:11264
    v_cvt_pk_bf16_f32 v208, v208, v209
    v_mfma_f32_16x16x32_bf16 v[52:55], a[72:75], a[148:151], 0
    v_cvt_pk_bf16_f32 v209, v210, v211
    v_pk_max_i16 v208, v208, 0
    v_pk_max_i16 v209, v209, 0
    ds_write_b64 v14, v[208:209] offset:49152
    v_cvt_pk_bf16_f32 v212, v212, v213
    v_mfma_f32_16x16x32_bf16 v[56:59], a[72:75], a[152:155], 0
    v_cvt_pk_bf16_f32 v213, v214, v215
    v_pk_max_i16 v212, v212, 0
    v_mfma_f32_16x16x32_bf16 v[60:63], a[72:75], a[156:159], 0
    buffer_load_dwordx4 a[72:75], v2, s[12:15], s28 offen offset:2048
    s_waitcnt lgkmcnt(9)
    v_mfma_f32_16x16x32_bf16 v[48:51], a[76:79], a[160:163], v[48:51]
    ds_read_b128 a[192:195], v23 offset:12288
    ds_read_b128 a[196:199], v23 offset:13312
    ds_read_b128 a[200:203], v23 offset:14336
    ds_read_b128 a[204:207], v23 offset:15360
    v_pk_max_i16 v213, v213, 0
    v_mfma_f32_16x16x32_bf16 v[52:55], a[76:79], a[164:167], v[52:55]
    ds_write_b64 v15, v[212:213] offset:49152
    v_cvt_pk_bf16_f32 v216, v216, v217
    v_cvt_pk_bf16_f32 v217, v218, v219
    v_pk_max_i16 v216, v216, 0
    v_pk_max_i16 v217, v217, 0
    v_mfma_f32_16x16x32_bf16 v[56:59], a[76:79], a[168:171], v[56:59]
    ds_write_b64 v16, v[216:217] offset:49152
    v_cvt_pk_bf16_f32 v220, v220, v221
    v_mfma_f32_16x16x32_bf16 v[60:63], a[76:79], a[172:175], v[60:63]
    buffer_load_dwordx4 a[76:79], v2, s[12:15], s28 offen offset:3072
    s_waitcnt vmcnt(40) lgkmcnt(7)
    v_mfma_f32_16x16x32_bf16 v[48:51], a[80:83], a[176:179], v[48:51]
    s_add_u32 s28, s28, 4096
    ds_read_b128 a[208:211], v23 offset:16384
    ds_read_b128 a[212:215], v23 offset:17408
    ds_read_b128 a[216:219], v23 offset:18432
    ds_read_b128 a[220:223], v23 offset:19456
    v_mfma_f32_16x16x32_bf16 v[52:55], a[80:83], a[180:183], v[52:55]
    v_cvt_pk_bf16_f32 v221, v222, v223
    v_pk_max_i16 v220, v220, 0
    v_pk_max_i16 v221, v221, 0
    ds_write_b64 v17, v[220:221] offset:49152
    v_cvt_pk_bf16_f32 v224, v224, v225
    v_mfma_f32_16x16x32_bf16 v[56:59], a[80:83], a[184:187], v[56:59]
    v_cvt_pk_bf16_f32 v225, v226, v227
    v_pk_max_i16 v224, v224, 0
    v_pk_max_i16 v225, v225, 0
    v_mfma_f32_16x16x32_bf16 v[60:63], a[80:83], a[188:191], v[60:63]
    buffer_load_dwordx4 a[80:83], v2, s[12:15], s28 offen offset:0
    s_waitcnt lgkmcnt(7)
    v_mfma_f32_16x16x32_bf16 v[48:51], a[84:87], a[192:195], v[48:51]
    ds_read_b128 a[224:227], v23 offset:20480
    ds_read_b128 a[228:231], v23 offset:21504
    ds_read_b128 a[232:235], v23 offset:22528
    ds_read_b128 a[236:239], v23 offset:23552
    ds_write_b64 v14, v[224:225] offset:57344
    v_mfma_f32_16x16x32_bf16 v[52:55], a[84:87], a[196:199], v[52:55]
    v_cvt_pk_bf16_f32 v228, v228, v229
    v_cvt_pk_bf16_f32 v229, v230, v231
    v_pk_max_i16 v228, v228, 0
    v_pk_max_i16 v229, v229, 0
    ds_write_b64 v15, v[228:229] offset:57344
    v_mfma_f32_16x16x32_bf16 v[56:59], a[84:87], a[200:203], v[56:59]
    v_cvt_pk_bf16_f32 v232, v232, v233
    v_cvt_pk_bf16_f32 v233, v234, v235
    v_mfma_f32_16x16x32_bf16 v[60:63], a[84:87], a[204:207], v[60:63]
    buffer_load_dwordx4 a[84:87], v2, s[12:15], s28 offen offset:1024
    s_waitcnt vmcnt(40) lgkmcnt(7)
    v_mfma_f32_16x16x32_bf16 v[48:51], a[88:91], a[208:211], v[48:51]
    ds_read_b128 a[240:243], v23 offset:24576
    ds_read_b128 a[244:247], v23 offset:25600
    ds_read_b128 a[248:251], v23 offset:26624
    ds_read_b128 a[252:255], v23 offset:27648
    v_pk_max_i16 v232, v232, 0
    v_mfma_f32_16x16x32_bf16 v[52:55], a[88:91], a[212:215], v[52:55]
    v_pk_max_i16 v233, v233, 0
    ds_write_b64 v16, v[232:233] offset:57344
    v_cvt_pk_bf16_f32 v236, v236, v237
    v_cvt_pk_bf16_f32 v237, v238, v239
    v_pk_max_i16 v236, v236, 0
    v_mfma_f32_16x16x32_bf16 v[56:59], a[88:91], a[216:219], v[56:59]
    v_pk_max_i16 v237, v237, 0
    ds_write_b64 v17, v[236:237] offset:57344
    v_mfma_f32_16x16x32_bf16 v[60:63], a[88:91], a[220:223], v[60:63]
    buffer_load_dwordx4 a[88:91], v2, s[12:15], s28 offen offset:2048
    s_waitcnt lgkmcnt(8)
    v_mfma_f32_16x16x32_bf16 v[48:51], a[92:95], a[224:227], v[48:51]
    ds_read_b128 v[80:83], v23 offset:28672
    ds_read_b128 v[84:87], v23 offset:29696
    ds_read_b128 v[88:91], v23 offset:30720
    ds_read_b128 v[92:95], v23 offset:31744
    v_add_u32 v14, 8192, v14
    v_mfma_f32_16x16x32_bf16 v[52:55], a[92:95], a[228:231], v[52:55]
    v_cvt_pk_bf16_f32 v240, v240, v241
    v_cvt_pk_bf16_f32 v241, v242, v243
    v_pk_max_i16 v240, v240, 0
    v_pk_max_i16 v241, v241, 0
    ds_write_b64 v14, v[240:241] offset:57344
    v_mfma_f32_16x16x32_bf16 v[56:59], a[92:95], a[232:235], v[56:59]
    v_add_u32 v15, 8192, v15
    v_cvt_pk_bf16_f32 v244, v244, v245
    v_mfma_f32_16x16x32_bf16 v[60:63], a[92:95], a[236:239], v[60:63]
    buffer_load_dwordx4 a[92:95], v2, s[12:15], s28 offen offset:3072
    s_waitcnt vmcnt(40) lgkmcnt(7)
    v_mfma_f32_16x16x32_bf16 v[48:51], a[96:99], a[240:243], v[48:51]
    s_add_u32 s28, s28, 4096
    ds_read_b128 v[96:99], v23 offset:32768
    ds_read_b128 v[100:103], v23 offset:33792
    ds_read_b128 v[104:107], v23 offset:34816
    ds_read_b128 v[108:111], v23 offset:35840
    v_mfma_f32_16x16x32_bf16 v[52:55], a[96:99], a[244:247], v[52:55]
    v_cvt_pk_bf16_f32 v245, v246, v247
    v_pk_max_i16 v244, v244, 0
    v_pk_max_i16 v245, v245, 0
    ds_write_b64 v15, v[244:245] offset:57344
    v_add_u32 v16, 8192, v16
    v_mfma_f32_16x16x32_bf16 v[56:59], a[96:99], a[248:251], v[56:59]
    v_cvt_pk_bf16_f32 v248, v248, v249
    v_cvt_pk_bf16_f32 v249, v250, v251
    v_pk_max_i16 v248, v248, 0
    v_mfma_f32_16x16x32_bf16 v[60:63], a[96:99], a[252:255], v[60:63]
    buffer_load_dwordx4 a[96:99], v2, s[12:15], s28 offen offset:0
    s_waitcnt lgkmcnt(6)
    v_mfma_f32_16x16x32_bf16 v[48:51], a[100:103], v[80:83], v[48:51]
    ds_read_b128 v[112:115], v23 offset:36864
    ds_read_b128 v[116:119], v23 offset:37888
    ds_read_b128 v[120:123], v23 offset:38912
    ds_read_b128 v[124:127], v23 offset:39936
    v_pk_max_i16 v249, v249, 0
    v_mfma_f32_16x16x32_bf16 v[52:55], a[100:103], v[84:87], v[52:55]
    ds_write_b64 v16, v[248:249] offset:57344
    v_add_u32 v17, 8192, v17
    v_cvt_pk_bf16_f32 v252, v252, v253
    v_cvt_pk_bf16_f32 v253, v254, v255
    v_pk_max_i16 v252, v252, 0
    v_mfma_f32_16x16x32_bf16 v[56:59], a[100:103], v[88:91], v[56:59]
    v_pk_max_i16 v253, v253, 0
    ds_write_b64 v17, v[252:253] offset:57344
    v_mfma_f32_16x16x32_bf16 v[60:63], a[100:103], v[92:95], v[60:63]
    s_waitcnt vmcnt(39) lgkmcnt(7)
    v_mfma_f32_16x16x32_bf16 v[48:51], a[104:107], v[96:99], v[48:51]
    s_waitcnt lgkmcnt(0)
    s_barrier
    ds_read_b128 v[128:131], v23 offset:40960
    ds_read_b128 v[132:135], v23 offset:41984
    ds_read_b128 v[136:139], v23 offset:43008
    v_mfma_f32_16x16x32_bf16 v[52:55], a[104:107], v[100:103], v[52:55]
    ds_read_b128 v[140:143], v23 offset:44032
    v_mfma_f32_16x16x32_bf16 v[56:59], a[104:107], v[104:107], v[56:59]
    v_mfma_f32_16x16x32_bf16 v[60:63], a[104:107], v[108:111], v[60:63]
    buffer_load_dwordx4 a[100:103], v2, s[12:15], s28 offen offset:1024
    s_waitcnt lgkmcnt(6)
    v_mfma_f32_16x16x32_bf16 v[48:51], a[108:111], v[112:115], v[48:51]
    ds_read_b128 v[144:147], v23 offset:45056
    ds_read_b128 v[148:151], v23 offset:46080
    ds_read_b128 v[152:155], v23 offset:47104
    ds_read_b128 v[156:159], v23 offset:48128
    v_mfma_f32_16x16x32_bf16 v[52:55], a[108:111], v[116:119], v[52:55]
    v_mfma_f32_16x16x32_bf16 v[56:59], a[108:111], v[120:123], v[56:59]
    v_mfma_f32_16x16x32_bf16 v[60:63], a[108:111], v[124:127], v[60:63]
    buffer_load_dwordx4 a[104:107], v2, s[12:15], s28 offen offset:2048
    s_waitcnt vmcnt(39) lgkmcnt(4)
    v_mfma_f32_16x16x32_bf16 v[48:51], a[112:115], v[128:131], v[48:51]
    ds_read_b128 v[160:163], v23 offset:49152
    ds_read_b128 v[164:167], v23 offset:50176
    ds_read_b128 v[168:171], v23 offset:51200
    ds_read_b128 v[172:175], v23 offset:52224
    v_mfma_f32_16x16x32_bf16 v[52:55], a[112:115], v[132:135], v[52:55]
    v_mfma_f32_16x16x32_bf16 v[56:59], a[112:115], v[136:139], v[56:59]
    v_mfma_f32_16x16x32_bf16 v[60:63], a[112:115], v[140:143], v[60:63]
    buffer_load_dwordx4 a[108:111], v2, s[12:15], s28 offen offset:3072
    s_waitcnt lgkmcnt(4)
    v_mfma_f32_16x16x32_bf16 v[48:51], a[116:119], v[144:147], v[48:51]
    s_add_u32 s28, s28, 4096
    ds_read_b128 v[176:179], v23 offset:53248
    ds_read_b128 v[180:183], v23 offset:54272
    ds_read_b128 v[184:187], v23 offset:55296
    ds_read_b128 v[188:191], v23 offset:56320
    v_mfma_f32_16x16x32_bf16 v[52:55], a[116:119], v[148:151], v[52:55]
    v_mfma_f32_16x16x32_bf16 v[56:59], a[116:119], v[152:155], v[56:59]
    v_mfma_f32_16x16x32_bf16 v[60:63], a[116:119], v[156:159], v[60:63]
    buffer_load_dwordx4 a[112:115], v2, s[12:15], s28 offen offset:0
    s_waitcnt vmcnt(39) lgkmcnt(4)
    v_mfma_f32_16x16x32_bf16 v[48:51], a[120:123], v[160:163], v[48:51]
    ds_read_b128 v[192:195], v23 offset:57344
    ds_read_b128 v[196:199], v23 offset:58368
    ds_read_b128 v[200:203], v23 offset:59392
    ds_read_b128 v[204:207], v23 offset:60416
    v_mfma_f32_16x16x32_bf16 v[52:55], a[120:123], v[164:167], v[52:55]
    v_mfma_f32_16x16x32_bf16 v[56:59], a[120:123], v[168:171], v[56:59]
    v_mfma_f32_16x16x32_bf16 v[60:63], a[120:123], v[172:175], v[60:63]
    buffer_load_dwordx4 a[116:119], v2, s[12:15], s28 offen offset:1024
    s_waitcnt lgkmcnt(4)
    v_mfma_f32_16x16x32_bf16 v[48:51], a[124:127], v[176:179], v[48:51]
    ds_read_b128 v[208:211], v23 offset:61440
    ds_read_b128 v[212:215], v23 offset:62464
    ds_read_b128 v[216:219], v23 offset:63488
    ds_read_b128 v[220:223], v23 offset:64512
    v_mfma_f32_16x16x32_bf16 v[52:55], a[124:127], v[180:183], v[52:55]
    v_mfma_f32_16x16x32_bf16 v[56:59], a[124:127], v[184:187], v[56:59]
    v_mfma_f32_16x16x32_bf16 v[60:63], a[124:127], v[188:191], v[60:63]
    buffer_load_dwordx4 a[120:123], v2, s[12:15], s28 offen offset:2048
    s_waitcnt vmcnt(39) lgkmcnt(4)
    v_mfma_f32_16x16x32_bf16 v[48:51], a[128:131], v[192:195], v[48:51]
    v_add_u32 v23, 0x10000, v23
    ds_read_b128 v[224:227], v23 offset:0
    ds_read_b128 v[228:231], v23 offset:1024
    ds_read_b128 v[232:235], v23 offset:2048
    ds_read_b128 v[236:239], v23 offset:3072
    v_mfma_f32_16x16x32_bf16 v[52:55], a[128:131], v[196:199], v[52:55]
    v_mfma_f32_16x16x32_bf16 v[56:59], a[128:131], v[200:203], v[56:59]
    v_mfma_f32_16x16x32_bf16 v[60:63], a[128:131], v[204:207], v[60:63]
    s_waitcnt lgkmcnt(4)
    v_mfma_f32_16x16x32_bf16 v[48:51], a[132:135], v[208:211], v[48:51]
    ds_read_b128 v[240:243], v23 offset:4096
    ds_read_b128 v[244:247], v23 offset:5120
    ds_read_b128 v[248:251], v23 offset:6144
    ds_read_b128 v[252:255], v23 offset:7168
    v_mfma_f32_16x16x32_bf16 v[52:55], a[132:135], v[212:215], v[52:55]
    v_mfma_f32_16x16x32_bf16 v[56:59], a[132:135], v[216:219], v[56:59]
    v_mfma_f32_16x16x32_bf16 v[60:63], a[132:135], v[220:223], v[60:63]
    buffer_load_dwordx4 a[124:127], v2, s[12:15], s28 offen offset:3072
    s_waitcnt vmcnt(38) lgkmcnt(4)
    v_mfma_f32_16x16x32_bf16 v[48:51], a[136:139], v[224:227], v[48:51]
    s_add_u32 s28, s28, 4096
    v_mfma_f32_16x16x32_bf16 v[52:55], a[136:139], v[228:231], v[52:55]
    v_mfma_f32_16x16x32_bf16 v[56:59], a[136:139], v[232:235], v[56:59]
    v_mfma_f32_16x16x32_bf16 v[60:63], a[136:139], v[236:239], v[60:63]
    buffer_load_dwordx4 a[128:131], v2, s[12:15], s28 offen offset:0
    s_waitcnt lgkmcnt(0)
    v_mfma_f32_16x16x32_bf16 v[48:51], a[140:143], v[240:243], v[48:51]
    v_mfma_f32_16x16x32_bf16 v[52:55], a[140:143], v[244:247], v[52:55]
    v_mfma_f32_16x16x32_bf16 v[56:59], a[140:143], v[248:251], v[56:59]
    v_mfma_f32_16x16x32_bf16 v[60:63], a[140:143], v[252:255], v[60:63]
    buffer_load_dwordx4 a[132:135], v2, s[12:15], s28 offen offset:1024
    s_waitcnt vmcnt(38)
    v_mfma_f32_16x16x32_bf16 v[32:35], a[0:3], a[144:147], 0
    v_mfma_f32_16x16x32_bf16 v[36:39], a[0:3], a[148:151], 0
    v_mfma_f32_16x16x32_bf16 v[40:43], a[0:3], a[152:155], 0
    v_mfma_f32_16x16x32_bf16 v[44:47], a[0:3], a[156:159], 0
    buffer_load_dwordx4 a[136:139], v2, s[12:15], s28 offen offset:2048
    v_mfma_f32_16x16x32_bf16 v[32:35], a[4:7], a[160:163], v[32:35]
    v_cvt_pk_bf16_f32 v24, v48, v49
    v_cvt_pk_bf16_f32 v25, v50, v51
    v_mfma_f32_16x16x32_bf16 v[36:39], a[4:7], a[164:167], v[36:39]
    v_cvt_pk_bf16_f32 v26, v52, v53
    v_cvt_pk_bf16_f32 v27, v54, v55
    v_mfma_f32_16x16x32_bf16 v[40:43], a[4:7], a[168:171], v[40:43]
    buffer_store_dwordx4 v[24:27], v2, s[12:15], s43 offen offset:0 sc1
    v_mfma_f32_16x16x32_bf16 v[44:47], a[4:7], a[172:175], v[44:47]
    buffer_load_dwordx4 a[140:143], v2, s[12:15], s28 offen offset:3072
    s_waitcnt vmcnt(39)
    v_mfma_f32_16x16x32_bf16 v[32:35], a[8:11], a[176:179], v[32:35]
    s_add_u32 s28, s28, 4096
    v_cvt_pk_bf16_f32 v28, v56, v57
    v_mfma_f32_16x16x32_bf16 v[36:39], a[8:11], a[180:183], v[36:39]
    v_cvt_pk_bf16_f32 v29, v58, v59
    v_cvt_pk_bf16_f32 v30, v60, v61
    v_mfma_f32_16x16x32_bf16 v[40:43], a[8:11], a[184:187], v[40:43]
    v_cvt_pk_bf16_f32 v31, v62, v63
    buffer_store_dwordx4 v[28:31], v2, s[12:15], s43 offen offset:1024 sc1
    v_mfma_f32_16x16x32_bf16 v[44:47], a[8:11], a[188:191], v[44:47]
    buffer_load_dwordx4 a[0:3], v2, s[12:15], s28 offen offset:0
    v_mfma_f32_16x16x32_bf16 v[32:35], a[12:15], a[192:195], v[32:35]
    v_mfma_f32_16x16x32_bf16 v[36:39], a[12:15], a[196:199], v[36:39]
    v_mfma_f32_16x16x32_bf16 v[40:43], a[12:15], a[200:203], v[40:43]
    v_mfma_f32_16x16x32_bf16 v[44:47], a[12:15], a[204:207], v[44:47]
    s_waitcnt vmcnt(39)
    v_mfma_f32_16x16x32_bf16 v[32:35], a[16:19], a[208:211], v[32:35]
    v_mfma_f32_16x16x32_bf16 v[36:39], a[16:19], a[212:215], v[36:39]
    v_mfma_f32_16x16x32_bf16 v[40:43], a[16:19], a[216:219], v[40:43]
    v_mfma_f32_16x16x32_bf16 v[44:47], a[16:19], a[220:223], v[44:47]
    buffer_load_dwordx4 a[4:7], v2, s[12:15], s28 offen offset:1024
    v_mfma_f32_16x16x32_bf16 v[32:35], a[20:23], a[224:227], v[32:35]
    v_mfma_f32_16x16x32_bf16 v[36:39], a[20:23], a[228:231], v[36:39]
    v_mfma_f32_16x16x32_bf16 v[40:43], a[20:23], a[232:235], v[40:43]
    v_mfma_f32_16x16x32_bf16 v[44:47], a[20:23], a[236:239], v[44:47]
    buffer_load_dwordx4 a[8:11], v2, s[12:15], s28 offen offset:2048
    s_waitcnt vmcnt(39)
    v_mfma_f32_16x16x32_bf16 v[32:35], a[24:27], a[240:243], v[32:35]
    v_mfma_f32_16x16x32_bf16 v[36:39], a[24:27], a[244:247], v[36:39]
    v_mfma_f32_16x16x32_bf16 v[40:43], a[24:27], a[248:251], v[40:43]
    v_mfma_f32_16x16x32_bf16 v[44:47], a[24:27], a[252:255], v[44:47]
    buffer_load_dwordx4 a[12:15], v2, s[12:15], s28 offen offset:3072
    v_mfma_f32_16x16x32_bf16 v[32:35], a[28:31], v[80:83], v[32:35]
    s_add_u32 s28, s28, 4096
    v_mfma_f32_16x16x32_bf16 v[36:39], a[28:31], v[84:87], v[36:39]
    v_mfma_f32_16x16x32_bf16 v[40:43], a[28:31], v[88:91], v[40:43]
    v_mfma_f32_16x16x32_bf16 v[44:47], a[28:31], v[92:95], v[44:47]
    buffer_load_dwordx4 a[16:19], v2, s[12:15], s28 offen offset:0
    s_waitcnt vmcnt(39)
    v_mfma_f32_16x16x32_bf16 v[32:35], a[32:35], v[96:99], v[32:35]
    v_mfma_f32_16x16x32_bf16 v[36:39], a[32:35], v[100:103], v[36:39]
    v_mfma_f32_16x16x32_bf16 v[40:43], a[32:35], v[104:107], v[40:43]
    v_mfma_f32_16x16x32_bf16 v[44:47], a[32:35], v[108:111], v[44:47]
    buffer_load_dwordx4 a[20:23], v2, s[12:15], s28 offen offset:1024
    v_mfma_f32_16x16x32_bf16 v[32:35], a[36:39], v[112:115], v[32:35]
    v_mfma_f32_16x16x32_bf16 v[36:39], a[36:39], v[116:119], v[36:39]
    v_mfma_f32_16x16x32_bf16 v[40:43], a[36:39], v[120:123], v[40:43]
    v_mfma_f32_16x16x32_bf16 v[44:47], a[36:39], v[124:127], v[44:47]
    buffer_load_dwordx4 a[24:27], v2, s[12:15], s28 offen offset:2048
    s_waitcnt vmcnt(39)
    v_mfma_f32_16x16x32_bf16 v[32:35], a[40:43], v[128:131], v[32:35]
    v_mfma_f32_16x16x32_bf16 v[36:39], a[40:43], v[132:135], v[36:39]
    v_mfma_f32_16x16x32_bf16 v[40:43], a[40:43], v[136:139], v[40:43]
    v_mfma_f32_16x16x32_bf16 v[44:47], a[40:43], v[140:143], v[44:47]
    v_mfma_f32_16x16x32_bf16 v[32:35], a[44:47], v[144:147], v[32:35]
    v_mfma_f32_16x16x32_bf16 v[36:39], a[44:47], v[148:151], v[36:39]
    v_mfma_f32_16x16x32_bf16 v[40:43], a[44:47], v[152:155], v[40:43]
    v_mfma_f32_16x16x32_bf16 v[44:47], a[44:47], v[156:159], v[44:47]
    buffer_load_dwordx4 a[28:31], v2, s[12:15], s28 offen offset:3072
    s_waitcnt vmcnt(38)
    v_mfma_f32_16x16x32_bf16 v[32:35], a[48:51], v[160:163], v[32:35]
    s_add_u32 s28, s28, 4096
    v_mfma_f32_16x16x32_bf16 v[36:39], a[48:51], v[164:167], v[36:39]
    v_mfma_f32_16x16x32_bf16 v[40:43], a[48:51], v[168:171], v[40:43]
    v_mfma_f32_16x16x32_bf16 v[44:47], a[48:51], v[172:175], v[44:47]
    buffer_load_dwordx4 a[32:35], v2, s[12:15], s28 offen offset:0
    v_mfma_f32_16x16x32_bf16 v[32:35], a[52:55], v[176:179], v[32:35]
    s_waitcnt vmcnt(63)
    buffer_store_dword v4, v3, s[12:15], s45 offen sc1
    v_mfma_f32_16x16x32_bf16 v[36:39], a[52:55], v[180:183], v[36:39]
    s_mov_b32 s45, s44
    s_add_u32 s46, s46, 1
    v_mfma_f32_16x16x32_bf16 v[40:43], a[52:55], v[184:187], v[40:43]
    s_and_b32 s46, s46, 7
    s_lshl_b32 s43, s46, 16
    v_mfma_f32_16x16x32_bf16 v[44:47], a[52:55], v[188:191], v[44:47]
    buffer_load_dwordx4 a[36:39], v2, s[12:15], s28 offen offset:1024
    s_waitcnt vmcnt(39)
    v_mfma_f32_16x16x32_bf16 v[32:35], a[56:59], v[192:195], v[32:35]
    s_add_u32 s43, s43, s40
    s_lshl_b32 s44, s46, 7
    v_mfma_f32_16x16x32_bf16 v[36:39], a[56:59], v[196:199], v[36:39]
    s_add_u32 s44, s44, s41
    v_mfma_f32_16x16x32_bf16 v[40:43], a[56:59], v[200:203], v[40:43]
    v_mfma_f32_16x16x32_bf16 v[44:47], a[56:59], v[204:207], v[44:47]
    buffer_load_dwordx4 a[40:43], v2, s[12:15], s28 offen offset:2048
    v_mfma_f32_16x16x32_bf16 v[32:35], a[60:63], v[208:211], v[32:35]
    v_mfma_f32_16x16x32_bf16 v[36:39], a[60:63], v[212:215], v[36:39]
    v_mfma_f32_16x16x32_bf16 v[40:43], a[60:63], v[216:219], v[40:43]
    v_mfma_f32_16x16x32_bf16 v[44:47], a[60:63], v[220:223], v[44:47]
    buffer_load_dwordx4 a[44:47], v2, s[12:15], s28 offen offset:3072
    s_waitcnt vmcnt(39)
    v_mfma_f32_16x16x32_bf16 v[32:35], a[64:67], v[224:227], v[32:35]
    s_add_u32 s28, s28, 4096
    v_mfma_f32_16x16x32_bf16 v[36:39], a[64:67], v[228:231], v[36:39]
    v_mfma_f32_16x16x32_bf16 v[40:43], a[64:67], v[232:235], v[40:43]
    v_mfma_f32_16x16x32_bf16 v[44:47], a[64:67], v[236:239], v[44:47]
    buffer_load_dwordx4 a[48:51], v2, s[12:15], s28 offen offset:0
    v_mfma_f32_16x16x32_bf16 v[32:35], a[68:71], v[240:243], v[32:35]
    v_mfma_f32_16x16x32_bf16 v[36:39], a[68:71], v[244:247], v[36:39]
    v_mfma_f32_16x16x32_bf16 v[40:43], a[68:71], v[248:251], v[40:43]
    v_mfma_f32_16x16x32_bf16 v[44:47], a[68:71], v[252:255], v[44:47]
    s_waitcnt vmcnt(32)
    v_mfma_f32_16x16x32_bf16 v[48:51], a[72:75], a[144:147], 0
    v_mfma_f32_16x16x32_bf16 v[52:55], a[72:75], a[148:151], 0
    v_mfma_f32_16x16x32_bf16 v[56:59], a[72:75], a[152:155], 0
    v_mfma_f32_16x16x32_bf16 v[60:63], a[72:75], a[156:159], 0
    buffer_load_dwordx4 a[52:55], v2, s[12:15], s28 offen offset:1024
    v_mfma_f32_16x16x32_bf16 v[48:51], a[76:79], a[160:163], v[48:51]
    v_cvt_pk_bf16_f32 v24, v32, v33
    v_cvt_pk_bf16_f32 v25, v34, v35
    v_mfma_f32_16x16x32_bf16 v[52:55], a[76:79], a[164:167], v[52:55]
    v_cvt_pk_bf16_f32 v26, v36, v37
    v_cvt_pk_bf16_f32 v27, v38, v39
    v_mfma_f32_16x16x32_bf16 v[56:59], a[76:79], a[168:171], v[56:59]
    buffer_store_dwordx4 v[24:27], v2, s[12:15], s43 offen offset:0 sc1
    v_mfma_f32_16x16x32_bf16 v[60:63], a[76:79], a[172:175], v[60:63]
    buffer_load_dwordx4 a[56:59], v2, s[12:15], s28 offen offset:2048
    s_waitcnt vmcnt(33)
    v_mfma_f32_16x16x32_bf16 v[48:51], a[80:83], a[176:179], v[48:51]
    v_cvt_pk_bf16_f32 v28, v40, v41
    v_cvt_pk_bf16_f32 v29, v42, v43
    v_mfma_f32_16x16x32_bf16 v[52:55], a[80:83], a[180:183], v[52:55]
    v_cvt_pk_bf16_f32 v30, v44, v45
    v_cvt_pk_bf16_f32 v31, v46, v47
    v_mfma_f32_16x16x32_bf16 v[56:59], a[80:83], a[184:187], v[56:59]
    buffer_store_dwordx4 v[28:31], v2, s[12:15], s43 offen offset:1024 sc1
    v_mfma_f32_16x16x32_bf16 v[60:63], a[80:83], a[188:191], v[60:63]
    buffer_load_dwordx4 a[60:63], v2, s[12:15], s28 offen offset:3072
    v_mfma_f32_16x16x32_bf16 v[48:51], a[84:87], a[192:195], v[48:51]
    s_add_u32 s28, s28, 4096
    v_mfma_f32_16x16x32_bf16 v[52:55], a[84:87], a[196:199], v[52:55]
    v_mfma_f32_16x16x32_bf16 v[56:59], a[84:87], a[200:203], v[56:59]
    v_mfma_f32_16x16x32_bf16 v[60:63], a[84:87], a[204:207], v[60:63]
    buffer_load_dwordx4 a[64:67], v2, s[12:15], s28 offen offset:0
    s_waitcnt vmcnt(34)
    v_mfma_f32_16x16x32_bf16 v[48:51], a[88:91], a[208:211], v[48:51]
    v_mfma_f32_16x16x32_bf16 v[52:55], a[88:91], a[212:215], v[52:55]
    v_mfma_f32_16x16x32_bf16 v[56:59], a[88:91], a[216:219], v[56:59]
    v_mfma_f32_16x16x32_bf16 v[60:63], a[88:91], a[220:223], v[60:63]
    buffer_load_dwordx4 a[68:71], v2, s[12:15], s28 offen offset:1024
    v_mfma_f32_16x16x32_bf16 v[48:51], a[92:95], a[224:227], v[48:51]
    v_mfma_f32_16x16x32_bf16 v[52:55], a[92:95], a[228:231], v[52:55]
    v_mfma_f32_16x16x32_bf16 v[56:59], a[92:95], a[232:235], v[56:59]
    v_mfma_f32_16x16x32_bf16 v[60:63], a[92:95], a[236:239], v[60:63]
    buffer_load_dwordx4 a[72:75], v2, s[12:15], s28 offen offset:2048
    s_waitcnt vmcnt(34)
    v_mfma_f32_16x16x32_bf16 v[48:51], a[96:99], a[240:243], v[48:51]
    v_mfma_f32_16x16x32_bf16 v[52:55], a[96:99], a[244:247], v[52:55]
    v_mfma_f32_16x16x32_bf16 v[56:59], a[96:99], a[248:251], v[56:59]
    v_mfma_f32_16x16x32_bf16 v[60:63], a[96:99], a[252:255], v[60:63]
    v_mfma_f32_16x16x32_bf16 v[48:51], a[100:103], v[80:83], v[48:51]
    v_mfma_f32_16x16x32_bf16 v[52:55], a[100:103], v[84:87], v[52:55]
    v_mfma_f32_16x16x32_bf16 v[56:59], a[100:103], v[88:91], v[56:59]
    v_mfma_f32_16x16x32_bf16 v[60:63], a[100:103], v[92:95], v[60:63]
    buffer_load_dwordx4 a[76:79], v2, s[12:15], s28 offen offset:3072
    s_waitcnt vmcnt(33)
    v_mfma_f32_16x16x32_bf16 v[48:51], a[104:107], v[96:99], v[48:51]
    s_add_u32 s28, s28, 4096
    v_mfma_f32_16x16x32_bf16 v[52:55], a[104:107], v[100:103], v[52:55]
    v_mfma_f32_16x16x32_bf16 v[56:59], a[104:107], v[104:107], v[56:59]
    v_mfma_f32_16x16x32_bf16 v[60:63], a[104:107], v[108:111], v[60:63]
    buffer_load_dwordx4 a[80:83], v2, s[12:15], s28 offen offset:0
    v_mfma_f32_16x16x32_bf16 v[48:51], a[108:111], v[112:115], v[48:51]
    v_mfma_f32_16x16x32_bf16 v[52:55], a[108:111], v[116:119], v[52:55]
    v_mfma_f32_16x16x32_bf16 v[56:59], a[108:111], v[120:123], v[56:59]
    v_mfma_f32_16x16x32_bf16 v[60:63], a[108:111], v[124:127], v[60:63]
    buffer_load_dwordx4 a[84:87], v2, s[12:15], s28 offen offset:1024
    s_waitcnt vmcnt(33)
    v_mfma_f32_16x16x32_bf16 v[48:51], a[112:115], v[128:131], v[48:51]
    v_mfma_f32_16x16x32_bf16 v[52:55], a[112:115], v[132:135], v[52:55]
    v_mfma_f32_16x16x32_bf16 v[56:59], a[112:115], v[136:139], v[56:59]
    v_mfma_f32_16x16x32_bf16 v[60:63], a[112:115], v[140:143], v[60:63]
    buffer_load_dwordx4 a[88:91], v2, s[12:15], s28 offen offset:2048
    v_mfma_f32_16x16x32_bf16 v[48:51], a[116:119], v[144:147], v[48:51]
    v_mfma_f32_16x16x32_bf16 v[52:55], a[116:119], v[148:151], v[52:55]
    v_mfma_f32_16x16x32_bf16 v[56:59], a[116:119], v[152:155], v[56:59]
    v_mfma_f32_16x16x32_bf16 v[60:63], a[116:119], v[156:159], v[60:63]
    buffer_load_dwordx4 a[92:95], v2, s[12:15], s28 offen offset:3072
    s_waitcnt vmcnt(33)
    v_mfma_f32_16x16x32_bf16 v[48:51], a[120:123], v[160:163], v[48:51]
    s_add_u32 s28, s28, 4096
    v_mfma_f32_16x16x32_bf16 v[52:55], a[120:123], v[164:167], v[52:55]
    v_mfma_f32_16x16x32_bf16 v[56:59], a[120:123], v[168:171], v[56:59]
    v_mfma_f32_16x16x32_bf16 v[60:63], a[120:123], v[172:175], v[60:63]
    buffer_load_dwordx4 a[96:99], v2, s[12:15], s28 offen offset:0
    v_mfma_f32_16x16x32_bf16 v[48:51], a[124:127], v[176:179], v[48:51]
    s_waitcnt vmcnt(28)
    buffer_store_dword v4, v3, s[12:15], s45 offen sc1
    v_mfma_f32_16x16x32_bf16 v[52:55], a[124:127], v[180:183], v[52:55]
    s_mov_b32 s45, s44
    s_add_u32 s46, s46, 1
    v_mfma_f32_16x16x32_bf16 v[56:59], a[124:127], v[184:187], v[56:59]
    s_and_b32 s46, s46, 7
    s_lshl_b32 s43, s46, 16
    v_mfma_f32_16x16x32_bf16 v[60:63], a[124:127], v[188:191], v[60:63]
    s_add_u32 s43, s43, s40
    s_waitcnt vmcnt(33)
    v_mfma_f32_16x16x32_bf16 v[48:51], a[128:131], v[192:195], v[48:51]
    s_lshl_b32 s44, s46, 7
    s_add_u32 s44, s44, s41
    v_mfma_f32_16x16x32_bf16 v[52:55], a[128:131], v[196:199], v[52:55]
    v_mfma_f32_16x16x32_bf16 v[56:59], a[128:131], v[200:203], v[56:59]
    v_mfma_f32_16x16x32_bf16 v[60:63], a[128:131], v[204:207], v[60:63]
    buffer_load_dwordx4 a[100:103], v2, s[12:15], s28 offen offset:1024
    v_mfma_f32_16x16x32_bf16 v[48:51], a[132:135], v[208:211], v[48:51]
    v_mfma_f32_16x16x32_bf16 v[52:55], a[132:135], v[212:215], v[52:55]
    v_mfma_f32_16x16x32_bf16 v[56:59], a[132:135], v[216:219], v[56:59]
    v_mfma_f32_16x16x32_bf16 v[60:63], a[132:135], v[220:223], v[60:63]
    buffer_load_dwordx4 a[104:107], v2, s[12:15], s28 offen offset:2048
    s_waitcnt vmcnt(32)
    v_mfma_f32_16x16x32_bf16 v[48:51], a[136:139], v[224:227], v[48:51]
    v_mfma_f32_16x16x32_bf16 v[52:55], a[136:139], v[228:231], v[52:55]
    v_mfma_f32_16x16x32_bf16 v[56:59], a[136:139], v[232:235], v[56:59]
    v_mfma_f32_16x16x32_bf16 v[60:63], a[136:139], v[236:239], v[60:63]
    buffer_load_dwordx4 a[108:111], v2, s[12:15], s28 offen offset:3072
    v_mfma_f32_16x16x32_bf16 v[48:51], a[140:143], v[240:243], v[48:51]
    s_add_u32 s28, s28, 4096
    v_mfma_f32_16x16x32_bf16 v[52:55], a[140:143], v[244:247], v[52:55]
    v_mfma_f32_16x16x32_bf16 v[56:59], a[140:143], v[248:251], v[56:59]
    v_mfma_f32_16x16x32_bf16 v[60:63], a[140:143], v[252:255], v[60:63]
    buffer_load_dwordx4 a[112:115], v2, s[12:15], s28 offen offset:0
    s_waitcnt vmcnt(31)
    v_mfma_f32_16x16x32_bf16 v[32:35], a[0:3], a[144:147], 0
    v_mfma_f32_16x16x32_bf16 v[36:39], a[0:3], a[148:151], 0
    v_mfma_f32_16x16x32_bf16 v[40:43], a[0:3], a[152:155], 0
    v_mfma_f32_16x16x32_bf16 v[44:47], a[0:3], a[156:159], 0
    buffer_load_dwordx4 a[116:119], v2, s[12:15], s28 offen offset:1024
    v_mfma_f32_16x16x32_bf16 v[32:35], a[4:7], a[160:163], v[32:35]
    v_cvt_pk_bf16_f32 v24, v48, v49
    v_cvt_pk_bf16_f32 v25, v50, v51
    v_mfma_f32_16x16x32_bf16 v[36:39], a[4:7], a[164:167], v[36:39]
    v_cvt_pk_bf16_f32 v26, v52, v53
    v_cvt_pk_bf16_f32 v27, v54, v55
    v_mfma_f32_16x16x32_bf16 v[40:43], a[4:7], a[168:171], v[40:43]
    buffer_store_dwordx4 v[24:27], v2, s[12:15], s43 offen offset:0 sc1
    v_mfma_f32_16x16x32_bf16 v[44:47], a[4:7], a[172:175], v[44:47]
    buffer_load_dwordx4 a[120:123], v2, s[12:15], s28 offen offset:2048
    s_waitcnt vmcnt(32)
    v_mfma_f32_16x16x32_bf16 v[32:35], a[8:11], a[176:179], v[32:35]
    v_cvt_pk_bf16_f32 v28, v56, v57
    v_cvt_pk_bf16_f32 v29, v58, v59
    v_mfma_f32_16x16x32_bf16 v[36:39], a[8:11], a[180:183], v[36:39]
    v_cvt_pk_bf16_f32 v30, v60, v61
    v_cvt_pk_bf16_f32 v31, v62, v63
    v_mfma_f32_16x16x32_bf16 v[40:43], a[8:11], a[184:187], v[40:43]
    buffer_store_dwordx4 v[28:31], v2, s[12:15], s43 offen offset:1024 sc1
    v_mfma_f32_16x16x32_bf16 v[44:47], a[8:11], a[188:191], v[44:47]
    v_mfma_f32_16x16x32_bf16 v[32:35], a[12:15], a[192:195], v[32:35]
    v_mfma_f32_16x16x32_bf16 v[36:39], a[12:15], a[196:199], v[36:39]
    v_mfma_f32_16x16x32_bf16 v[40:43], a[12:15], a[200:203], v[40:43]
    v_mfma_f32_16x16x32_bf16 v[44:47], a[12:15], a[204:207], v[44:47]
    buffer_load_dwordx4 a[124:127], v2, s[12:15], s28 offen offset:3072
    s_waitcnt vmcnt(32)
    v_mfma_f32_16x16x32_bf16 v[32:35], a[16:19], a[208:211], v[32:35]
    s_add_u32 s28, s28, 4096
    v_mfma_f32_16x16x32_bf16 v[36:39], a[16:19], a[212:215], v[36:39]
    v_mfma_f32_16x16x32_bf16 v[40:43], a[16:19], a[216:219], v[40:43]
    v_mfma_f32_16x16x32_bf16 v[44:47], a[16:19], a[220:223], v[44:47]
    buffer_load_dwordx4 a[128:131], v2, s[12:15], s28 offen offset:0
    v_mfma_f32_16x16x32_bf16 v[32:35], a[20:23], a[224:227], v[32:35]
    v_mfma_f32_16x16x32_bf16 v[36:39], a[20:23], a[228:231], v[36:39]
    v_mfma_f32_16x16x32_bf16 v[40:43], a[20:23], a[232:235], v[40:43]
    v_mfma_f32_16x16x32_bf16 v[44:47], a[20:23], a[236:239], v[44:47]
    buffer_load_dwordx4 a[132:135], v2, s[12:15], s28 offen offset:1024
    s_waitcnt vmcnt(32)
    v_mfma_f32_16x16x32_bf16 v[32:35], a[24:27], a[240:243], v[32:35]
    v_mfma_f32_16x16x32_bf16 v[36:39], a[24:27], a[244:247], v[36:39]
    v_mfma_f32_16x16x32_bf16 v[40:43], a[24:27], a[248:251], v[40:43]
    v_mfma_f32_16x16x32_bf16 v[44:47], a[24:27], a[252:255], v[44:47]
    buffer_load_dwordx4 a[136:139], v2, s[12:15], s28 offen offset:2048
    v_mfma_f32_16x16x32_bf16 v[32:35], a[28:31], v[80:83], v[32:35]
    v_mfma_f32_16x16x32_bf16 v[36:39], a[28:31], v[84:87], v[36:39]
    v_mfma_f32_16x16x32_bf16 v[40:43], a[28:31], v[88:91], v[40:43]
    v_mfma_f32_16x16x32_bf16 v[44:47], a[28:31], v[92:95], v[44:47]
    buffer_load_dwordx4 a[140:143], v2, s[12:15], s28 offen offset:3072
    s_waitcnt vmcnt(31)
    v_mfma_f32_16x16x32_bf16 v[32:35], a[32:35], v[96:99], v[32:35]
    s_add_u32 s28, s28, 4096
    v_mfma_f32_16x16x32_bf16 v[36:39], a[32:35], v[100:103], v[36:39]
    v_mfma_f32_16x16x32_bf16 v[40:43], a[32:35], v[104:107], v[40:43]
    v_mfma_f32_16x16x32_bf16 v[44:47], a[32:35], v[108:111], v[44:47]
    buffer_load_dwordx4 a[0:3], v2, s[12:15], s28 offen offset:0
    v_mfma_f32_16x16x32_bf16 v[32:35], a[36:39], v[112:115], v[32:35]
    v_mfma_f32_16x16x32_bf16 v[36:39], a[36:39], v[116:119], v[36:39]
    v_mfma_f32_16x16x32_bf16 v[40:43], a[36:39], v[120:123], v[40:43]
    v_mfma_f32_16x16x32_bf16 v[44:47], a[36:39], v[124:127], v[44:47]
    s_waitcnt vmcnt(30)
    v_mfma_f32_16x16x32_bf16 v[32:35], a[40:43], v[128:131], v[32:35]
    v_mfma_f32_16x16x32_bf16 v[36:39], a[40:43], v[132:135], v[36:39]
    v_mfma_f32_16x16x32_bf16 v[40:43], a[40:43], v[136:139], v[40:43]
    v_mfma_f32_16x16x32_bf16 v[44:47], a[40:43], v[140:143], v[44:47]
    buffer_load_dwordx4 a[4:7], v2, s[12:15], s28 offen offset:1024
    v_mfma_f32_16x16x32_bf16 v[32:35], a[44:47], v[144:147], v[32:35]
    v_mfma_f32_16x16x32_bf16 v[36:39], a[44:47], v[148:151], v[36:39]
    v_mfma_f32_16x16x32_bf16 v[40:43], a[44:47], v[152:155], v[40:43]
    v_mfma_f32_16x16x32_bf16 v[44:47], a[44:47], v[156:159], v[44:47]
    buffer_load_dwordx4 a[8:11], v2, s[12:15], s28 offen offset:2048
    s_waitcnt vmcnt(30)
    v_mfma_f32_16x16x32_bf16 v[32:35], a[48:51], v[160:163], v[32:35]
    v_mfma_f32_16x16x32_bf16 v[36:39], a[48:51], v[164:167], v[36:39]
    v_mfma_f32_16x16x32_bf16 v[40:43], a[48:51], v[168:171], v[40:43]
    v_mfma_f32_16x16x32_bf16 v[44:47], a[48:51], v[172:175], v[44:47]
    buffer_load_dwordx4 a[12:15], v2, s[12:15], s28 offen offset:3072
    v_mfma_f32_16x16x32_bf16 v[32:35], a[52:55], v[176:179], v[32:35]
    s_add_u32 s28, s28, 4096
    s_waitcnt vmcnt(28)
    v_mfma_f32_16x16x32_bf16 v[36:39], a[52:55], v[180:183], v[36:39]
    buffer_store_dword v4, v3, s[12:15], s45 offen sc1
    v_mfma_f32_16x16x32_bf16 v[40:43], a[52:55], v[184:187], v[40:43]
    s_mov_b32 s45, s44
    s_add_u32 s46, s46, 1
    v_mfma_f32_16x16x32_bf16 v[44:47], a[52:55], v[188:191], v[44:47]
    buffer_load_dwordx4 a[16:19], v2, s[12:15], s28 offen offset:0
    s_waitcnt vmcnt(29)
    v_mfma_f32_16x16x32_bf16 v[32:35], a[56:59], v[192:195], v[32:35]
    s_and_b32 s46, s46, 7
    s_lshl_b32 s43, s46, 16
    v_mfma_f32_16x16x32_bf16 v[36:39], a[56:59], v[196:199], v[36:39]
    s_add_u32 s43, s43, s40
    s_lshl_b32 s44, s46, 7
    v_mfma_f32_16x16x32_bf16 v[40:43], a[56:59], v[200:203], v[40:43]
    s_add_u32 s44, s44, s41
    v_mfma_f32_16x16x32_bf16 v[44:47], a[56:59], v[204:207], v[44:47]
    buffer_load_dwordx4 a[20:23], v2, s[12:15], s28 offen offset:1024
    v_mfma_f32_16x16x32_bf16 v[32:35], a[60:63], v[208:211], v[32:35]
    v_mfma_f32_16x16x32_bf16 v[36:39], a[60:63], v[212:215], v[36:39]
    v_mfma_f32_16x16x32_bf16 v[40:43], a[60:63], v[216:219], v[40:43]
    v_mfma_f32_16x16x32_bf16 v[44:47], a[60:63], v[220:223], v[44:47]
    buffer_load_dwordx4 a[24:27], v2, s[12:15], s28 offen offset:2048
    s_waitcnt vmcnt(29)
    v_mfma_f32_16x16x32_bf16 v[32:35], a[64:67], v[224:227], v[32:35]
    v_mfma_f32_16x16x32_bf16 v[36:39], a[64:67], v[228:231], v[36:39]
    v_mfma_f32_16x16x32_bf16 v[40:43], a[64:67], v[232:235], v[40:43]
    v_mfma_f32_16x16x32_bf16 v[44:47], a[64:67], v[236:239], v[44:47]
    v_mfma_f32_16x16x32_bf16 v[32:35], a[68:71], v[240:243], v[32:35]
    v_mfma_f32_16x16x32_bf16 v[36:39], a[68:71], v[244:247], v[36:39]
    v_mfma_f32_16x16x32_bf16 v[40:43], a[68:71], v[248:251], v[40:43]
    v_mfma_f32_16x16x32_bf16 v[44:47], a[68:71], v[252:255], v[44:47]
    buffer_load_dwordx4 a[28:31], v2, s[12:15], s28 offen offset:3072
    s_waitcnt vmcnt(28)
    v_mfma_f32_16x16x32_bf16 v[48:51], a[72:75], a[144:147], 0
    s_add_u32 s28, s28, 4096
    v_mfma_f32_16x16x32_bf16 v[52:55], a[72:75], a[148:151], 0
    v_mfma_f32_16x16x32_bf16 v[56:59], a[72:75], a[152:155], 0
    v_mfma_f32_16x16x32_bf16 v[60:63], a[72:75], a[156:159], 0
    buffer_load_dwordx4 a[32:35], v2, s[12:15], s28 offen offset:0
    v_mfma_f32_16x16x32_bf16 v[48:51], a[76:79], a[160:163], v[48:51]
    v_cvt_pk_bf16_f32 v24, v32, v33
    v_cvt_pk_bf16_f32 v25, v34, v35
    v_mfma_f32_16x16x32_bf16 v[52:55], a[76:79], a[164:167], v[52:55]
    v_cvt_pk_bf16_f32 v26, v36, v37
    v_cvt_pk_bf16_f32 v27, v38, v39
    v_mfma_f32_16x16x32_bf16 v[56:59], a[76:79], a[168:171], v[56:59]
    buffer_store_dwordx4 v[24:27], v2, s[12:15], s43 offen offset:0 sc1
    v_mfma_f32_16x16x32_bf16 v[60:63], a[76:79], a[172:175], v[60:63]
    buffer_load_dwordx4 a[36:39], v2, s[12:15], s28 offen offset:1024
    s_waitcnt vmcnt(29)
    v_mfma_f32_16x16x32_bf16 v[48:51], a[80:83], a[176:179], v[48:51]
    v_cvt_pk_bf16_f32 v28, v40, v41
    v_cvt_pk_bf16_f32 v29, v42, v43
    v_mfma_f32_16x16x32_bf16 v[52:55], a[80:83], a[180:183], v[52:55]
    v_cvt_pk_bf16_f32 v30, v44, v45
    v_cvt_pk_bf16_f32 v31, v46, v47
    v_mfma_f32_16x16x32_bf16 v[56:59], a[80:83], a[184:187], v[56:59]
    buffer_store_dwordx4 v[28:31], v2, s[12:15], s43 offen offset:1024 sc1
    v_mfma_f32_16x16x32_bf16 v[60:63], a[80:83], a[188:191], v[60:63]
    buffer_load_dwordx4 a[40:43], v2, s[12:15], s28 offen offset:2048
    v_mfma_f32_16x16x32_bf16 v[48:51], a[84:87], a[192:195], v[48:51]
    v_mfma_f32_16x16x32_bf16 v[52:55], a[84:87], a[196:199], v[52:55]
    v_mfma_f32_16x16x32_bf16 v[56:59], a[84:87], a[200:203], v[56:59]
    v_mfma_f32_16x16x32_bf16 v[60:63], a[84:87], a[204:207], v[60:63]
    buffer_load_dwordx4 a[44:47], v2, s[12:15], s28 offen offset:3072
    s_waitcnt vmcnt(30)
    v_mfma_f32_16x16x32_bf16 v[48:51], a[88:91], a[208:211], v[48:51]
    s_add_u32 s28, s28, 4096
    v_mfma_f32_16x16x32_bf16 v[52:55], a[88:91], a[212:215], v[52:55]
    v_mfma_f32_16x16x32_bf16 v[56:59], a[88:91], a[216:219], v[56:59]
    v_mfma_f32_16x16x32_bf16 v[60:63], a[88:91], a[220:223], v[60:63]
    buffer_load_dwordx4 a[48:51], v2, s[12:15], s28 offen offset:0
    v_mfma_f32_16x16x32_bf16 v[48:51], a[92:95], a[224:227], v[48:51]
    v_mfma_f32_16x16x32_bf16 v[52:55], a[92:95], a[228:231], v[52:55]
    v_mfma_f32_16x16x32_bf16 v[56:59], a[92:95], a[232:235], v[56:59]
    v_mfma_f32_16x16x32_bf16 v[60:63], a[92:95], a[236:239], v[60:63]
    s_waitcnt vmcnt(28)
    v_mfma_f32_16x16x32_bf16 v[48:51], a[96:99], a[240:243], v[48:51]
    v_mfma_f32_16x16x32_bf16 v[52:55], a[96:99], a[244:247], v[52:55]
    v_mfma_f32_16x16x32_bf16 v[56:59], a[96:99], a[248:251], v[56:59]
    v_mfma_f32_16x16x32_bf16 v[60:63], a[96:99], a[252:255], v[60:63]
    buffer_load_dwordx4 a[52:55], v2, s[12:15], s28 offen offset:1024
    v_mfma_f32_16x16x32_bf16 v[48:51], a[100:103], v[80:83], v[48:51]
    v_mfma_f32_16x16x32_bf16 v[52:55], a[100:103], v[84:87], v[52:55]
    v_mfma_f32_16x16x32_bf16 v[56:59], a[100:103], v[88:91], v[56:59]
    v_mfma_f32_16x16x32_bf16 v[60:63], a[100:103], v[92:95], v[60:63]
    buffer_load_dwordx4 a[56:59], v2, s[12:15], s28 offen offset:2048
    s_waitcnt vmcnt(28)
    v_mfma_f32_16x16x32_bf16 v[48:51], a[104:107], v[96:99], v[48:51]
    v_mfma_f32_16x16x32_bf16 v[52:55], a[104:107], v[100:103], v[52:55]
    v_mfma_f32_16x16x32_bf16 v[56:59], a[104:107], v[104:107], v[56:59]
    v_mfma_f32_16x16x32_bf16 v[60:63], a[104:107], v[108:111], v[60:63]
    buffer_load_dwordx4 a[60:63], v2, s[12:15], s28 offen offset:3072
    v_mfma_f32_16x16x32_bf16 v[48:51], a[108:111], v[112:115], v[48:51]
    s_add_u32 s28, s28, 4096
    v_mfma_f32_16x16x32_bf16 v[52:55], a[108:111], v[116:119], v[52:55]
    v_mfma_f32_16x16x32_bf16 v[56:59], a[108:111], v[120:123], v[56:59]
    v_mfma_f32_16x16x32_bf16 v[60:63], a[108:111], v[124:127], v[60:63]
    buffer_load_dwordx4 a[64:67], v2, s[12:15], s28 offen offset:0
    s_waitcnt vmcnt(28)
    v_mfma_f32_16x16x32_bf16 v[48:51], a[112:115], v[128:131], v[48:51]
    v_mfma_f32_16x16x32_bf16 v[52:55], a[112:115], v[132:135], v[52:55]
    v_mfma_f32_16x16x32_bf16 v[56:59], a[112:115], v[136:139], v[56:59]
    v_mfma_f32_16x16x32_bf16 v[60:63], a[112:115], v[140:143], v[60:63]
    buffer_load_dwordx4 a[68:71], v2, s[12:15], s28 offen offset:1024
    v_mfma_f32_16x16x32_bf16 v[48:51], a[116:119], v[144:147], v[48:51]
    v_mfma_f32_16x16x32_bf16 v[52:55], a[116:119], v[148:151], v[52:55]
    v_mfma_f32_16x16x32_bf16 v[56:59], a[116:119], v[152:155], v[56:59]
    v_mfma_f32_16x16x32_bf16 v[60:63], a[116:119], v[156:159], v[60:63]
    buffer_load_dwordx4 a[72:75], v2, s[12:15], s28 offen offset:2048
    s_waitcnt vmcnt(26)
    v_mfma_f32_16x16x32_bf16 v[48:51], a[120:123], v[160:163], v[48:51]
    v_mfma_f32_16x16x32_bf16 v[52:55], a[120:123], v[164:167], v[52:55]
    v_mfma_f32_16x16x32_bf16 v[56:59], a[120:123], v[168:171], v[56:59]
    v_mfma_f32_16x16x32_bf16 v[60:63], a[120:123], v[172:175], v[60:63]
    v_mfma_f32_16x16x32_bf16 v[48:51], a[124:127], v[176:179], v[48:51]
    s_waitcnt vmcnt(27)
    buffer_store_dword v4, v3, s[12:15], s45 offen sc1
    v_mfma_f32_16x16x32_bf16 v[52:55], a[124:127], v[180:183], v[52:55]
    s_mov_b32 s45, s44
    s_add_u32 s46, s46, 1
    v_mfma_f32_16x16x32_bf16 v[56:59], a[124:127], v[184:187], v[56:59]
    s_and_b32 s46, s46, 7
    s_lshl_b32 s43, s46, 16
    v_mfma_f32_16x16x32_bf16 v[60:63], a[124:127], v[188:191], v[60:63]
    buffer_load_dwordx4 a[76:79], v2, s[12:15], s28 offen offset:3072
    s_waitcnt vmcnt(26)
    v_mfma_f32_16x16x32_bf16 v[48:51], a[128:131], v[192:195], v[48:51]
    s_add_u32 s28, s28, 4096
    s_add_u32 s43, s43, s40
    v_mfma_f32_16x16x32_bf16 v[52:55], a[128:131], v[196:199], v[52:55]
    s_lshl_b32 s44, s46, 7
    s_add_u32 s44, s44, s41
    v_mfma_f32_16x16x32_bf16 v[56:59], a[128:131], v[200:203], v[56:59]
    v_mfma_f32_16x16x32_bf16 v[60:63], a[128:131], v[204:207], v[60:63]
    buffer_load_dwordx4 a[80:83], v2, s[12:15], s28 offen offset:0
    v_mfma_f32_16x16x32_bf16 v[48:51], a[132:135], v[208:211], v[48:51]
    v_mfma_f32_16x16x32_bf16 v[52:55], a[132:135], v[212:215], v[52:55]
    v_mfma_f32_16x16x32_bf16 v[56:59], a[132:135], v[216:219], v[56:59]
    v_mfma_f32_16x16x32_bf16 v[60:63], a[132:135], v[220:223], v[60:63]
    buffer_load_dwordx4 a[84:87], v2, s[12:15], s28 offen offset:1024
    s_waitcnt vmcnt(26)
    v_mfma_f32_16x16x32_bf16 v[48:51], a[136:139], v[224:227], v[48:51]
    v_mfma_f32_16x16x32_bf16 v[52:55], a[136:139], v[228:231], v[52:55]
    v_mfma_f32_16x16x32_bf16 v[56:59], a[136:139], v[232:235], v[56:59]
    v_mfma_f32_16x16x32_bf16 v[60:63], a[136:139], v[236:239], v[60:63]
    buffer_load_dwordx4 a[88:91], v2, s[12:15], s28 offen offset:2048
    v_mfma_f32_16x16x32_bf16 v[48:51], a[140:143], v[240:243], v[48:51]
    v_mfma_f32_16x16x32_bf16 v[52:55], a[140:143], v[244:247], v[52:55]
    v_mfma_f32_16x16x32_bf16 v[56:59], a[140:143], v[248:251], v[56:59]
    v_mfma_f32_16x16x32_bf16 v[60:63], a[140:143], v[252:255], v[60:63]
    buffer_load_dwordx4 a[92:95], v2, s[12:15], s28 offen offset:3072
    s_waitcnt vmcnt(26)
    v_mfma_f32_16x16x32_bf16 v[32:35], a[0:3], a[144:147], 0
    s_add_u32 s28, s28, 4096
    v_mfma_f32_16x16x32_bf16 v[36:39], a[0:3], a[148:151], 0
    v_mfma_f32_16x16x32_bf16 v[40:43], a[0:3], a[152:155], 0
    v_mfma_f32_16x16x32_bf16 v[44:47], a[0:3], a[156:159], 0
    buffer_load_dwordx4 a[96:99], v2, s[12:15], s28 offen offset:0
    v_mfma_f32_16x16x32_bf16 v[32:35], a[4:7], a[160:163], v[32:35]
    v_cvt_pk_bf16_f32 v24, v48, v49
    v_cvt_pk_bf16_f32 v25, v50, v51
    v_mfma_f32_16x16x32_bf16 v[36:39], a[4:7], a[164:167], v[36:39]
    v_cvt_pk_bf16_f32 v26, v52, v53
    v_cvt_pk_bf16_f32 v27, v54, v55
    v_mfma_f32_16x16x32_bf16 v[40:43], a[4:7], a[168:171], v[40:43]
    buffer_store_dwordx4 v[24:27], v2, s[12:15], s43 offen offset:0 sc1
    v_mfma_f32_16x16x32_bf16 v[44:47], a[4:7], a[172:175], v[44:47]
    v_cvt_pk_bf16_f32 v28, v56, v57
    s_waitcnt vmcnt(26)
    v_mfma_f32_16x16x32_bf16 v[32:35], a[8:11], a[176:179], v[32:35]
    v_cvt_pk_bf16_f32 v29, v58, v59
    v_cvt_pk_bf16_f32 v30, v60, v61
    v_mfma_f32_16x16x32_bf16 v[36:39], a[8:11], a[180:183], v[36:39]
    v_cvt_pk_bf16_f32 v31, v62, v63
    buffer_store_dwordx4 v[28:31], v2, s[12:15], s43 offen offset:1024 sc1
    v_mfma_f32_16x16x32_bf16 v[40:43], a[8:11], a[184:187], v[40:43]
    v_mfma_f32_16x16x32_bf16 v[44:47], a[8:11], a[188:191], v[44:47]
    buffer_load_dwordx4 a[100:103], v2, s[12:15], s28 offen offset:1024
    v_mfma_f32_16x16x32_bf16 v[32:35], a[12:15], a[192:195], v[32:35]
    v_mfma_f32_16x16x32_bf16 v[36:39], a[12:15], a[196:199], v[36:39]
    v_mfma_f32_16x16x32_bf16 v[40:43], a[12:15], a[200:203], v[40:43]
    v_mfma_f32_16x16x32_bf16 v[44:47], a[12:15], a[204:207], v[44:47]
    buffer_load_dwordx4 a[104:107], v2, s[12:15], s28 offen offset:2048
    s_waitcnt vmcnt(26)
    v_mfma_f32_16x16x32_bf16 v[32:35], a[16:19], a[208:211], v[32:35]
    v_mfma_f32_16x16x32_bf16 v[36:39], a[16:19], a[212:215], v[36:39]
    v_mfma_f32_16x16x32_bf16 v[40:43], a[16:19], a[216:219], v[40:43]
    v_mfma_f32_16x16x32_bf16 v[44:47], a[16:19], a[220:223], v[44:47]
    buffer_load_dwordx4 a[108:111], v2, s[12:15], s28 offen offset:3072
    v_mfma_f32_16x16x32_bf16 v[32:35], a[20:23], a[224:227], v[32:35]
    s_add_u32 s28, s28, 4096
    v_mfma_f32_16x16x32_bf16 v[36:39], a[20:23], a[228:231], v[36:39]
    v_mfma_f32_16x16x32_bf16 v[40:43], a[20:23], a[232:235], v[40:43]
    v_mfma_f32_16x16x32_bf16 v[44:47], a[20:23], a[236:239], v[44:47]
    buffer_load_dwordx4 a[112:115], v2, s[12:15], s28 offen offset:0
    s_waitcnt vmcnt(26)
    v_mfma_f32_16x16x32_bf16 v[32:35], a[24:27], a[240:243], v[32:35]
    v_mfma_f32_16x16x32_bf16 v[36:39], a[24:27], a[244:247], v[36:39]
    v_mfma_f32_16x16x32_bf16 v[40:43], a[24:27], a[248:251], v[40:43]
    v_mfma_f32_16x16x32_bf16 v[44:47], a[24:27], a[252:255], v[44:47]
    buffer_load_dwordx4 a[116:119], v2, s[12:15], s28 offen offset:1024
    v_mfma_f32_16x16x32_bf16 v[32:35], a[28:31], v[80:83], v[32:35]
    v_mfma_f32_16x16x32_bf16 v[36:39], a[28:31], v[84:87], v[36:39]
    v_mfma_f32_16x16x32_bf16 v[40:43], a[28:31], v[88:91], v[40:43]
    v_mfma_f32_16x16x32_bf16 v[44:47], a[28:31], v[92:95], v[44:47]
    buffer_load_dwordx4 a[120:123], v2, s[12:15], s28 offen offset:2048
    s_waitcnt vmcnt(25)
    v_mfma_f32_16x16x32_bf16 v[32:35], a[32:35], v[96:99], v[32:35]
    v_mfma_f32_16x16x32_bf16 v[36:39], a[32:35], v[100:103], v[36:39]
    v_mfma_f32_16x16x32_bf16 v[40:43], a[32:35], v[104:107], v[40:43]
    v_mfma_f32_16x16x32_bf16 v[44:47], a[32:35], v[108:111], v[44:47]
    v_mfma_f32_16x16x32_bf16 v[32:35], a[36:39], v[112:115], v[32:35]
    v_mfma_f32_16x16x32_bf16 v[36:39], a[36:39], v[116:119], v[36:39]
    v_mfma_f32_16x16x32_bf16 v[40:43], a[36:39], v[120:123], v[40:43]
    v_mfma_f32_16x16x32_bf16 v[44:47], a[36:39], v[124:127], v[44:47]
    buffer_load_dwordx4 a[124:127], v2, s[12:15], s28 offen offset:3072
    s_waitcnt vmcnt(23)
    v_mfma_f32_16x16x32_bf16 v[32:35], a[40:43], v[128:131], v[32:35]
    s_add_u32 s28, s28, 4096
    v_mfma_f32_16x16x32_bf16 v[36:39], a[40:43], v[132:135], v[36:39]
    v_mfma_f32_16x16x32_bf16 v[40:43], a[40:43], v[136:139], v[40:43]
    v_mfma_f32_16x16x32_bf16 v[44:47], a[40:43], v[140:143], v[44:47]
    buffer_load_dwordx4 a[128:131], v2, s[12:15], s28 offen offset:0
    v_mfma_f32_16x16x32_bf16 v[32:35], a[44:47], v[144:147], v[32:35]
    v_mfma_f32_16x16x32_bf16 v[36:39], a[44:47], v[148:151], v[36:39]
    v_mfma_f32_16x16x32_bf16 v[40:43], a[44:47], v[152:155], v[40:43]
    v_mfma_f32_16x16x32_bf16 v[44:47], a[44:47], v[156:159], v[44:47]
    buffer_load_dwordx4 a[132:135], v2, s[12:15], s28 offen offset:1024
    s_waitcnt vmcnt(23)
    v_mfma_f32_16x16x32_bf16 v[32:35], a[48:51], v[160:163], v[32:35]
    v_mfma_f32_16x16x32_bf16 v[36:39], a[48:51], v[164:167], v[36:39]
    v_mfma_f32_16x16x32_bf16 v[40:43], a[48:51], v[168:171], v[40:43]
    v_mfma_f32_16x16x32_bf16 v[44:47], a[48:51], v[172:175], v[44:47]
    buffer_load_dwordx4 a[136:139], v2, s[12:15], s28 offen offset:2048
    v_mfma_f32_16x16x32_bf16 v[32:35], a[52:55], v[176:179], v[32:35]
    s_waitcnt vmcnt(28)
    buffer_store_dword v4, v3, s[12:15], s45 offen sc1
    v_mfma_f32_16x16x32_bf16 v[36:39], a[52:55], v[180:183], v[36:39]
    s_mov_b32 s45, s44
    s_add_u32 s46, s46, 1
    v_mfma_f32_16x16x32_bf16 v[40:43], a[52:55], v[184:187], v[40:43]
    s_and_b32 s46, s46, 7
    s_lshl_b32 s43, s46, 16
    v_mfma_f32_16x16x32_bf16 v[44:47], a[52:55], v[188:191], v[44:47]
    buffer_load_dwordx4 a[140:143], v2, s[12:15], s28 offen offset:3072
    s_waitcnt vmcnt(24)
    v_mfma_f32_16x16x32_bf16 v[32:35], a[56:59], v[192:195], v[32:35]
    s_add_u32 s28, s28, 4096
    s_add_u32 s43, s43, s40
    v_mfma_f32_16x16x32_bf16 v[36:39], a[56:59], v[196:199], v[36:39]
    s_lshl_b32 s44, s46, 7
    s_add_u32 s44, s44, s41
    v_mfma_f32_16x16x32_bf16 v[40:43], a[56:59], v[200:203], v[40:43]
    v_mfma_f32_16x16x32_bf16 v[44:47], a[56:59], v[204:207], v[44:47]
    buffer_load_dwordx4 a[0:3], v2, s[12:15], s28 offen offset:0
    v_mfma_f32_16x16x32_bf16 v[32:35], a[60:63], v[208:211], v[32:35]
    v_mfma_f32_16x16x32_bf16 v[36:39], a[60:63], v[212:215], v[36:39]
    v_mfma_f32_16x16x32_bf16 v[40:43], a[60:63], v[216:219], v[40:43]
    v_mfma_f32_16x16x32_bf16 v[44:47], a[60:63], v[220:223], v[44:47]
    s_waitcnt vmcnt(23)
    v_mfma_f32_16x16x32_bf16 v[32:35], a[64:67], v[224:227], v[32:35]
    v_mfma_f32_16x16x32_bf16 v[36:39], a[64:67], v[228:231], v[36:39]
    v_mfma_f32_16x16x32_bf16 v[40:43], a[64:67], v[232:235], v[40:43]
    v_mfma_f32_16x16x32_bf16 v[44:47], a[64:67], v[236:239], v[44:47]
    buffer_load_dwordx4 a[4:7], v2, s[12:15], s28 offen offset:1024
    v_mfma_f32_16x16x32_bf16 v[32:35], a[68:71], v[240:243], v[32:35]
    v_mfma_f32_16x16x32_bf16 v[36:39], a[68:71], v[244:247], v[36:39]
    v_mfma_f32_16x16x32_bf16 v[40:43], a[68:71], v[248:251], v[40:43]
    v_mfma_f32_16x16x32_bf16 v[44:47], a[68:71], v[252:255], v[44:47]
    buffer_load_dwordx4 a[8:11], v2, s[12:15], s28 offen offset:2048
    s_waitcnt vmcnt(22)
    v_mfma_f32_16x16x32_bf16 v[48:51], a[72:75], a[144:147], 0
    v_mfma_f32_16x16x32_bf16 v[52:55], a[72:75], a[148:151], 0
    v_mfma_f32_16x16x32_bf16 v[56:59], a[72:75], a[152:155], 0
    v_mfma_f32_16x16x32_bf16 v[60:63], a[72:75], a[156:159], 0
    buffer_load_dwordx4 a[12:15], v2, s[12:15], s28 offen offset:3072
    v_mfma_f32_16x16x32_bf16 v[48:51], a[76:79], a[160:163], v[48:51]
    s_add_u32 s28, s28, 4096
    v_cvt_pk_bf16_f32 v24, v32, v33
    v_mfma_f32_16x16x32_bf16 v[52:55], a[76:79], a[164:167], v[52:55]
    v_cvt_pk_bf16_f32 v25, v34, v35
    v_cvt_pk_bf16_f32 v26, v36, v37
    v_mfma_f32_16x16x32_bf16 v[56:59], a[76:79], a[168:171], v[56:59]
    v_cvt_pk_bf16_f32 v27, v38, v39
    buffer_store_dwordx4 v[24:27], v2, s[12:15], s43 offen offset:0 sc1
    v_mfma_f32_16x16x32_bf16 v[60:63], a[76:79], a[172:175], v[60:63]
    buffer_load_dwordx4 a[16:19], v2, s[12:15], s28 offen offset:0
    s_waitcnt vmcnt(23)
    v_mfma_f32_16x16x32_bf16 v[48:51], a[80:83], a[176:179], v[48:51]
    v_cvt_pk_bf16_f32 v28, v40, v41
    v_cvt_pk_bf16_f32 v29, v42, v43
    v_mfma_f32_16x16x32_bf16 v[52:55], a[80:83], a[180:183], v[52:55]
    v_cvt_pk_bf16_f32 v30, v44, v45
    v_cvt_pk_bf16_f32 v31, v46, v47
    v_mfma_f32_16x16x32_bf16 v[56:59], a[80:83], a[184:187], v[56:59]
    buffer_store_dwordx4 v[28:31], v2, s[12:15], s43 offen offset:1024 sc1
    v_mfma_f32_16x16x32_bf16 v[60:63], a[80:83], a[188:191], v[60:63]
    buffer_load_dwordx4 a[20:23], v2, s[12:15], s28 offen offset:1024
    v_mfma_f32_16x16x32_bf16 v[48:51], a[84:87], a[192:195], v[48:51]
    v_mfma_f32_16x16x32_bf16 v[52:55], a[84:87], a[196:199], v[52:55]
    v_mfma_f32_16x16x32_bf16 v[56:59], a[84:87], a[200:203], v[56:59]
    v_mfma_f32_16x16x32_bf16 v[60:63], a[84:87], a[204:207], v[60:63]
    buffer_load_dwordx4 a[24:27], v2, s[12:15], s28 offen offset:2048
    s_waitcnt vmcnt(24)
    v_mfma_f32_16x16x32_bf16 v[48:51], a[88:91], a[208:211], v[48:51]
    v_mfma_f32_16x16x32_bf16 v[52:55], a[88:91], a[212:215], v[52:55]
    v_mfma_f32_16x16x32_bf16 v[56:59], a[88:91], a[216:219], v[56:59]
    v_mfma_f32_16x16x32_bf16 v[60:63], a[88:91], a[220:223], v[60:63]
    v_mfma_f32_16x16x32_bf16 v[48:51], a[92:95], a[224:227], v[48:51]
    v_mfma_f32_16x16x32_bf16 v[52:55], a[92:95], a[228:231], v[52:55]
    v_mfma_f32_16x16x32_bf16 v[56:59], a[92:95], a[232:235], v[56:59]
    v_mfma_f32_16x16x32_bf16 v[60:63], a[92:95], a[236:239], v[60:63]
    buffer_load_dwordx4 a[28:31], v2, s[12:15], s28 offen offset:3072
    s_waitcnt vmcnt(21)
    v_mfma_f32_16x16x32_bf16 v[48:51], a[96:99], a[240:243], v[48:51]
    s_add_u32 s28, s28, 4096
    v_mfma_f32_16x16x32_bf16 v[52:55], a[96:99], a[244:247], v[52:55]
    v_mfma_f32_16x16x32_bf16 v[56:59], a[96:99], a[248:251], v[56:59]
    v_mfma_f32_16x16x32_bf16 v[60:63], a[96:99], a[252:255], v[60:63]
    buffer_load_dwordx4 a[32:35], v2, s[12:15], s28 offen offset:0
    v_mfma_f32_16x16x32_bf16 v[48:51], a[100:103], v[80:83], v[48:51]
    v_mfma_f32_16x16x32_bf16 v[52:55], a[100:103], v[84:87], v[52:55]
    v_mfma_f32_16x16x32_bf16 v[56:59], a[100:103], v[88:91], v[56:59]
    v_mfma_f32_16x16x32_bf16 v[60:63], a[100:103], v[92:95], v[60:63]
    buffer_load_dwordx4 a[36:39], v2, s[12:15], s28 offen offset:1024
    s_waitcnt vmcnt(21)
    v_mfma_f32_16x16x32_bf16 v[48:51], a[104:107], v[96:99], v[48:51]
    v_mfma_f32_16x16x32_bf16 v[52:55], a[104:107], v[100:103], v[52:55]
    v_mfma_f32_16x16x32_bf16 v[56:59], a[104:107], v[104:107], v[56:59]
    v_mfma_f32_16x16x32_bf16 v[60:63], a[104:107], v[108:111], v[60:63]
    buffer_load_dwordx4 a[40:43], v2, s[12:15], s28 offen offset:2048
    v_mfma_f32_16x16x32_bf16 v[48:51], a[108:111], v[112:115], v[48:51]
    v_mfma_f32_16x16x32_bf16 v[52:55], a[108:111], v[116:119], v[52:55]
    v_mfma_f32_16x16x32_bf16 v[56:59], a[108:111], v[120:123], v[56:59]
    v_mfma_f32_16x16x32_bf16 v[60:63], a[108:111], v[124:127], v[60:63]
    buffer_load_dwordx4 a[44:47], v2, s[12:15], s28 offen offset:3072
    s_waitcnt vmcnt(21)
    v_mfma_f32_16x16x32_bf16 v[48:51], a[112:115], v[128:131], v[48:51]
    s_add_u32 s28, s28, 4096
    v_mfma_f32_16x16x32_bf16 v[52:55], a[112:115], v[132:135], v[52:55]
    v_mfma_f32_16x16x32_bf16 v[56:59], a[112:115], v[136:139], v[56:59]
    v_mfma_f32_16x16x32_bf16 v[60:63], a[112:115], v[140:143], v[60:63]
    buffer_load_dwordx4 a[48:51], v2, s[12:15], s28 offen offset:0
    v_mfma_f32_16x16x32_bf16 v[48:51], a[116:119], v[144:147], v[48:51]
    v_mfma_f32_16x16x32_bf16 v[52:55], a[116:119], v[148:151], v[52:55]
    v_mfma_f32_16x16x32_bf16 v[56:59], a[116:119], v[152:155], v[56:59]
    v_mfma_f32_16x16x32_bf16 v[60:63], a[116:119], v[156:159], v[60:63]
    s_waitcnt vmcnt(20)
    v_mfma_f32_16x16x32_bf16 v[48:51], a[120:123], v[160:163], v[48:51]
    v_mfma_f32_16x16x32_bf16 v[52:55], a[120:123], v[164:167], v[52:55]
    v_mfma_f32_16x16x32_bf16 v[56:59], a[120:123], v[168:171], v[56:59]
    v_mfma_f32_16x16x32_bf16 v[60:63], a[120:123], v[172:175], v[60:63]
    buffer_load_dwordx4 a[52:55], v2, s[12:15], s28 offen offset:1024
    v_mfma_f32_16x16x32_bf16 v[48:51], a[124:127], v[176:179], v[48:51]
    s_waitcnt vmcnt(28)
    buffer_store_dword v4, v3, s[12:15], s45 offen sc1
    v_mfma_f32_16x16x32_bf16 v[52:55], a[124:127], v[180:183], v[52:55]
    s_mov_b32 s45, s44
    s_add_u32 s46, s46, 1
    v_mfma_f32_16x16x32_bf16 v[56:59], a[124:127], v[184:187], v[56:59]
    s_and_b32 s46, s46, 7
    s_lshl_b32 s43, s46, 16
    v_mfma_f32_16x16x32_bf16 v[60:63], a[124:127], v[188:191], v[60:63]
    buffer_load_dwordx4 a[56:59], v2, s[12:15], s28 offen offset:2048
    s_waitcnt vmcnt(21)
    v_mfma_f32_16x16x32_bf16 v[48:51], a[128:131], v[192:195], v[48:51]
    s_add_u32 s43, s43, s40
    s_lshl_b32 s44, s46, 7
    v_mfma_f32_16x16x32_bf16 v[52:55], a[128:131], v[196:199], v[52:55]
    s_add_u32 s44, s44, s41
    v_mfma_f32_16x16x32_bf16 v[56:59], a[128:131], v[200:203], v[56:59]
    v_mfma_f32_16x16x32_bf16 v[60:63], a[128:131], v[204:207], v[60:63]
    buffer_load_dwordx4 a[60:63], v2, s[12:15], s28 offen offset:3072
    v_mfma_f32_16x16x32_bf16 v[48:51], a[132:135], v[208:211], v[48:51]
    s_add_u32 s28, s28, 4096
    v_mfma_f32_16x16x32_bf16 v[52:55], a[132:135], v[212:215], v[52:55]
    v_mfma_f32_16x16x32_bf16 v[56:59], a[132:135], v[216:219], v[56:59]
    v_mfma_f32_16x16x32_bf16 v[60:63], a[132:135], v[220:223], v[60:63]
    buffer_load_dwordx4 a[64:67], v2, s[12:15], s28 offen offset:0
    s_waitcnt vmcnt(20)
    v_mfma_f32_16x16x32_bf16 v[48:51], a[136:139], v[224:227], v[48:51]
    v_mfma_f32_16x16x32_bf16 v[52:55], a[136:139], v[228:231], v[52:55]
    v_mfma_f32_16x16x32_bf16 v[56:59], a[136:139], v[232:235], v[56:59]
    v_mfma_f32_16x16x32_bf16 v[60:63], a[136:139], v[236:239], v[60:63]
    buffer_load_dwordx4 a[68:71], v2, s[12:15], s28 offen offset:1024
    v_mfma_f32_16x16x32_bf16 v[48:51], a[140:143], v[240:243], v[48:51]
    s_add_u32 s21, s28, 8192
    v_mfma_f32_16x16x32_bf16 v[52:55], a[140:143], v[244:247], v[52:55]
    v_mfma_f32_16x16x32_bf16 v[56:59], a[140:143], v[248:251], v[56:59]
    v_mfma_f32_16x16x32_bf16 v[60:63], a[140:143], v[252:255], v[60:63]
    buffer_load_dwordx4 a[100:103], v2, s[12:15], s21 offen offset:1024
    s_waitcnt vmcnt(20)
    v_mfma_f32_16x16x32_bf16 v[32:35], a[0:3], a[144:147], 0
    v_mfma_f32_16x16x32_bf16 v[36:39], a[0:3], a[148:151], 0
    v_mfma_f32_16x16x32_bf16 v[40:43], a[0:3], a[152:155], 0
    v_mfma_f32_16x16x32_bf16 v[44:47], a[0:3], a[156:159], 0
    buffer_load_dwordx4 a[104:107], v2, s[12:15], s21 offen offset:2048
    v_mfma_f32_16x16x32_bf16 v[32:35], a[4:7], a[160:163], v[32:35]
    v_cvt_pk_bf16_f32 v24, v48, v49
    v_cvt_pk_bf16_f32 v25, v50, v51
    v_mfma_f32_16x16x32_bf16 v[36:39], a[4:7], a[164:167], v[36:39]
    v_cvt_pk_bf16_f32 v26, v52, v53
    v_cvt_pk_bf16_f32 v27, v54, v55
    v_mfma_f32_16x16x32_bf16 v[40:43], a[4:7], a[168:171], v[40:43]
    buffer_store_dwordx4 v[24:27], v2, s[12:15], s43 offen offset:0 sc1
    v_mfma_f32_16x16x32_bf16 v[44:47], a[4:7], a[172:175], v[44:47]
    buffer_load_dwordx4 a[108:111], v2, s[12:15], s21 offen offset:3072
    s_waitcnt vmcnt(21)
    v_mfma_f32_16x16x32_bf16 v[32:35], a[8:11], a[176:179], v[32:35]
    s_add_u32 s21, s28, 12288
    v_cvt_pk_bf16_f32 v28, v56, v57
    v_mfma_f32_16x16x32_bf16 v[36:39], a[8:11], a[180:183], v[36:39]
    v_cvt_pk_bf16_f32 v29, v58, v59
    v_cvt_pk_bf16_f32 v30, v60, v61
    v_mfma_f32_16x16x32_bf16 v[40:43], a[8:11], a[184:187], v[40:43]
    v_cvt_pk_bf16_f32 v31, v62, v63
    buffer_store_dwordx4 v[28:31], v2, s[12:15], s43 offen offset:1024 sc1
    v_mfma_f32_16x16x32_bf16 v[44:47], a[8:11], a[188:191], v[44:47]
    buffer_load_dwordx4 a[112:115], v2, s[12:15], s21 offen offset:0
    v_mfma_f32_16x16x32_bf16 v[32:35], a[12:15], a[192:195], v[32:35]
    s_add_u32 s46, s46, 1
    s_and_b32 s46, s46, 7
    v_mfma_f32_16x16x32_bf16 v[36:39], a[12:15], a[196:199], v[36:39]
    s_lshl_b32 s43, s46, 16
    s_add_u32 s43, s43, s40
    v_mfma_f32_16x16x32_bf16 v[40:43], a[12:15], a[200:203], v[40:43]
    s_lshl_b32 s31, s30, 11
    v_add_u32 v10, s31, v9
    v_mfma_f32_16x16x32_bf16 v[44:47], a[12:15], a[204:207], v[44:47]
    buffer_load_dwordx4 a[116:119], v2, s[12:15], s21 offen offset:1024
    s_waitcnt vmcnt(20)
    v_mfma_f32_16x16x32_bf16 v[32:35], a[16:19], a[208:211], v[32:35]
    v_xor_b32 v11, 32, v10
    v_xor_b32 v12, 64, v10
    v_mfma_f32_16x16x32_bf16 v[36:39], a[16:19], a[212:215], v[36:39]
    v_xor_b32 v13, 0x60, v10
    s_lshl_b32 s31, s25, 5
    v_mfma_f32_16x16x32_bf16 v[40:43], a[16:19], a[216:219], v[40:43]
    s_add_u32 s31, s31, 0x10000
    s_and_b32 s32, s17, 1
    v_mfma_f32_16x16x32_bf16 v[44:47], a[16:19], a[220:223], v[44:47]
    buffer_load_dwordx4 a[120:123], v2, s[12:15], s21 offen offset:2048
    v_mfma_f32_16x16x32_bf16 v[32:35], a[20:23], a[224:227], v[32:35]
    s_lshl_b32 s32, s32, 1
    s_lshr_b32 s33, s16, 1
    v_mfma_f32_16x16x32_bf16 v[36:39], a[20:23], a[228:231], v[36:39]
    s_add_u32 s32, s32, s33
    s_lshl_b32 s33, s32, 5
    v_mfma_f32_16x16x32_bf16 v[40:43], a[20:23], a[232:235], v[40:43]
    v_xor_b32 v14, s33, v9
    v_add_u32 v14, s31, v14
    v_mfma_f32_16x16x32_bf16 v[44:47], a[20:23], a[236:239], v[44:47]
    buffer_load_dwordx4 a[124:127], v2, s[12:15], s21 offen offset:3072
    s_waitcnt vmcnt(20)
    v_mfma_f32_16x16x32_bf16 v[32:35], a[24:27], a[240:243], v[32:35]
    s_add_u32 s21, s28, 16384
    v_sub_u32 v15, s17, v0
    v_mfma_f32_16x16x32_bf16 v[36:39], a[24:27], a[244:247], v[36:39]
    v_and_b32 v15, 7, v15
    v_lshlrev_b32 v15, 4, v15
    v_mfma_f32_16x16x32_bf16 v[40:43], a[24:27], a[248:251], v[40:43]
    s_lshl_b32 s34, s17, 7
    s_lshl_b32 s35, s16, 2
    v_mfma_f32_16x16x32_bf16 v[44:47], a[24:27], a[252:255], v[44:47]
    buffer_load_dwordx4 a[128:131], v2, s[12:15], s21 offen offset:0
    v_mfma_f32_16x16x32_bf16 v[32:35], a[28:31], v[80:83], v[32:35]
    s_add_u32 s34, s34, s35
    v_add_u32 v15, s34, v15
    v_mfma_f32_16x16x32_bf16 v[36:39], a[28:31], v[84:87], v[36:39]
    v_and_b32 v17, 7, v0
    v_mul_u32_u24 v17, 144, v17
    v_mfma_f32_16x16x32_bf16 v[40:43], a[28:31], v[88:91], v[40:43]
    s_lshr_b32 s34, s25, 4
    v_add_u32 v17, s34, v17
    v_mfma_f32_16x16x32_bf16 v[44:47], a[28:31], v[92:95], v[44:47]
    buffer_load_dwordx4 a[132:135], v2, s[12:15], s21 offen offset:1024
    s_waitcnt vmcnt(20)
    v_mfma_f32_16x16x32_bf16 v[32:35], a[32:35], v[96:99], v[32:35]
    v_cmp_gt_u32 vcc, 40, v0
    v_add_u32 v18, s17, v0
    v_mfma_f32_16x16x32_bf16 v[36:39], a[32:35], v[100:103], v[36:39]
    v_and_b32 v18, 7, v18
    v_mul_u32_u24 v18, 144, v18
    v_mfma_f32_16x16x32_bf16 v[40:43], a[32:35], v[104:107], v[40:43]
    v_add_u32 v18, s35, v18
    v_cndmask_b32 v17, v18, v17, vcc
    v_mfma_f32_16x16x32_bf16 v[44:47], a[32:35], v[108:111], v[44:47]
    buffer_load_dwordx4 a[136:139], v2, s[12:15], s21 offen offset:2048
    v_mfma_f32_16x16x32_bf16 v[32:35], a[36:39], v[112:115], v[32:35]
    v_and_b32 v18, 40, v0
    v_cmp_eq_u32 vcc, 0, v18
    v_mfma_f32_16x16x32_bf16 v[36:39], a[36:39], v[116:119], v[36:39]
    s_lshl_b32 s34, s18, 10
    s_add_u32 s34, s34, 39321600
    v_mfma_f32_16x16x32_bf16 v[40:43], a[36:39], v[120:123], v[40:43]
    v_cndmask_b32 v15, v17, v15, vcc
    s_mul_i32 s35, s18, 589824
    v_mfma_f32_16x16x32_bf16 v[44:47], a[36:39], v[124:127], v[44:47]
    buffer_load_dwordx4 a[140:143], v2, s[12:15], s21 offen offset:3072
    s_waitcnt vmcnt(20)
    v_mfma_f32_16x16x32_bf16 v[32:35], a[40:43], v[128:131], v[32:35]
    s_add_u32 s21, s28, 0
    s_add_u32 s35, s35, 20447232
    v_mfma_f32_16x16x32_bf16 v[36:39], a[40:43], v[132:135], v[36:39]
    s_lshl_b32 s36, s17, 16
    s_add_u32 s36, s36, s35
    v_mfma_f32_16x16x32_bf16 v[40:43], a[40:43], v[136:139], v[40:43]
    s_lshl_b32 s37, s16, 11
    s_add_u32 s36, s36, s37
    v_mfma_f32_16x16x32_bf16 v[44:47], a[40:43], v[140:143], v[44:47]
    buffer_load_dwordx4 a[72:75], v2, s[12:15], s21 offen offset:2048
    v_mfma_f32_16x16x32_bf16 v[32:35], a[44:47], v[144:147], v[32:35]
    s_lshl_b32 s37, s17, 10
    s_add_u32 s35, s35, s37
    v_mfma_f32_16x16x32_bf16 v[36:39], a[44:47], v[148:151], v[36:39]
    s_lshl_b32 s37, s16, 2
    s_add_u32 s35, s35, s37
    v_mfma_f32_16x16x32_bf16 v[40:43], a[44:47], v[152:155], v[40:43]
    s_add_u32 s35, s35, 524288
    s_mov_b32 s50, 0x3f80
    v_mfma_f32_16x16x32_bf16 v[44:47], a[44:47], v[156:159], v[44:47]
    buffer_load_dwordx4 a[76:79], v2, s[12:15], s21 offen offset:3072
    s_waitcnt vmcnt(20)
    v_mfma_f32_16x16x32_bf16 v[32:35], a[48:51], v[160:163], v[32:35]
    s_add_u32 s21, s28, 4096
    s_mov_b32 s51, 0x3f800000
    v_mfma_f32_16x16x32_bf16 v[36:39], a[48:51], v[164:167], v[36:39]
    v_mul_u32_u24 v16, 1152, v5
    v_lshl_add_u32 v16, v7, 3, v16
    v_mfma_f32_16x16x32_bf16 v[40:43], a[48:51], v[168:171], v[40:43]
    v_lshlrev_b32 v22, 4, v5
    v_add_u32 v22, 147464, v22
    v_mfma_f32_16x16x32_bf16 v[44:47], a[48:51], v[172:175], v[44:47]
    buffer_load_dwordx4 a[80:83], v2, s[12:15], s21 offen offset:0
    v_mfma_f32_16x16x32_bf16 v[32:35], a[52:55], v[176:179], v[32:35]
    s_lshl_b32 s37, s32, 8
    v_add_u32 v23, s37, v22
    v_mfma_f32_16x16x32_bf16 v[36:39], a[52:55], v[180:183], v[36:39]
    v_mov_b32 v20, 0
    v_mov_b32 v21, 0
    v_mfma_f32_16x16x32_bf16 v[40:43], a[52:55], v[184:187], v[40:43]
    s_lshl_b32 s23, s17, 8
    s_add_u32 s23, s23, s24
    v_mfma_f32_16x16x32_bf16 v[44:47], a[52:55], v[188:191], v[44:47]
    buffer_load_dwordx4 a[84:87], v2, s[12:15], s21 offen offset:1024
    s_waitcnt vmcnt(19)
    v_mfma_f32_16x16x32_bf16 v[32:35], a[56:59], v[192:195], v[32:35]
    s_add_u32 s23, s23, 7154944
    s_add_u32 s49, s25, s27
    v_mfma_f32_16x16x32_bf16 v[36:39], a[56:59], v[196:199], v[36:39]
    s_add_u32 s49, s49, 7156992
    ds_read_b64_tr_b16 v[70:71], v10
    v_mfma_f32_16x16x32_bf16 v[40:43], a[56:59], v[200:203], v[40:43]
    ds_read_b64_tr_b16 v[72:73], v11
    ds_read_b64_tr_b16 v[74:75], v12
    v_mfma_f32_16x16x32_bf16 v[44:47], a[56:59], v[204:207], v[44:47]
    buffer_load_dwordx4 a[88:91], v2, s[12:15], s21 offen offset:2048
    v_mfma_f32_16x16x32_bf16 v[32:35], a[60:63], v[208:211], v[32:35]
    ds_read_b64_tr_b16 v[76:77], v13
    ds_read_b64_tr_b16 v[78:79], v14
    v_mfma_f32_16x16x32_bf16 v[36:39], a[60:63], v[212:215], v[36:39]
    ds_read_b32 v10, v22 offset:0
    ds_read_b32 v11, v22 offset:256
    v_mfma_f32_16x16x32_bf16 v[40:43], a[60:63], v[216:219], v[40:43]
    ds_read_b32 v12, v22 offset:512
    ds_read_b32 v13, v22 offset:768
    v_mfma_f32_16x16x32_bf16 v[44:47], a[60:63], v[220:223], v[44:47]
    buffer_load_dwordx4 a[92:95], v2, s[12:15], s21 offen offset:3072
    s_waitcnt vmcnt(19)
    v_mfma_f32_16x16x32_bf16 v[32:35], a[64:67], v[224:227], v[32:35]
    s_add_u32 s21, s28, 8192
    ds_read_b32 v14, v23
    v_mfma_f32_16x16x32_bf16 v[36:39], a[64:67], v[228:231], v[36:39]
    buffer_load_dwordx4 v[64:67], v8, s[12:15], s23 offen sc1
    v_mfma_f32_16x16x32_bf16 v[40:43], a[64:67], v[232:235], v[40:43]
    buffer_load_dwordx2 v[68:69], v8, s[12:15], s49 offen sc1
    v_mfma_f32_16x16x32_bf16 v[44:47], a[64:67], v[236:239], v[44:47]
    buffer_load_dwordx4 a[96:99], v2, s[12:15], s21 offen offset:0
    v_mfma_f32_16x16x32_bf16 v[32:35], a[68:71], v[240:243], v[32:35]
    buffer_load_dword v19, v15, s[12:15], s34 offen sc1
    v_mfma_f32_16x16x32_bf16 v[36:39], a[68:71], v[244:247], v[36:39]
    v_mfma_f32_16x16x32_bf16 v[40:43], a[68:71], v[248:251], v[40:43]
    v_mfma_f32_16x16x32_bf16 v[44:47], a[68:71], v[252:255], v[44:47]
    s_waitcnt vmcnt(21)
    v_mfma_f32_16x16x32_bf16 v[48:51], a[100:103], v[80:83], 0
    v_mfma_f32_16x16x32_bf16 v[52:55], a[100:103], v[84:87], 0
    v_mfma_f32_16x16x32_bf16 v[56:59], a[100:103], v[88:91], 0
    v_mfma_f32_16x16x32_bf16 v[60:63], a[100:103], v[92:95], 0
    v_mfma_f32_16x16x32_bf16 v[48:51], a[104:107], v[96:99], v[48:51]
    v_cvt_pk_bf16_f32 v24, v32, v33
    v_cvt_pk_bf16_f32 v25, v34, v35
    v_mfma_f32_16x16x32_bf16 v[52:55], a[104:107], v[100:103], v[52:55]
    v_cvt_pk_bf16_f32 v26, v36, v37
    v_cvt_pk_bf16_f32 v27, v38, v39
    v_mfma_f32_16x16x32_bf16 v[56:59], a[104:107], v[104:107], v[56:59]
    buffer_store_dwordx4 v[24:27], v2, s[12:15], s43 offen offset:0 sc1
    v_mfma_f32_16x16x32_bf16 v[60:63], a[104:107], v[108:111], v[60:63]
    v_cvt_pk_bf16_f32 v28, v40, v41
    s_waitcnt vmcnt(18)
    v_mfma_f32_16x16x32_bf16 v[48:51], a[108:111], v[112:115], v[48:51]
    v_cvt_pk_bf16_f32 v29, v42, v43
    v_cvt_pk_bf16_f32 v30, v44, v45
    v_mfma_f32_16x16x32_bf16 v[52:55], a[108:111], v[116:119], v[52:55]
    v_cvt_pk_bf16_f32 v31, v46, v47
    buffer_store_dwordx4 v[28:31], v2, s[12:15], s43 offen offset:1024 sc1
    v_mfma_f32_16x16x32_bf16 v[56:59], a[108:111], v[120:123], v[56:59]
    s_mov_b32 s38, 0xff1e
    s_mov_b32 s39, 0x0e00
    v_mfma_f32_16x16x32_bf16 v[60:63], a[108:111], v[124:127], v[60:63]
    s_sub_u32 s52, s17, 1
    v_mfma_f32_16x16x32_bf16 v[48:51], a[112:115], v[128:131], v[48:51]
    s_and_b32 s52, s52, 7
    s_lshl_b32 s52, s52, 13
    v_mfma_f32_16x16x32_bf16 v[52:55], a[112:115], v[132:135], v[52:55]
    s_add_u32 s52, s52, s36
    s_sub_u32 s53, s17, 2
    v_mfma_f32_16x16x32_bf16 v[56:59], a[112:115], v[136:139], v[56:59]
    s_and_b32 s53, s53, 7
    s_lshl_b32 s53, s53, 13
    v_mfma_f32_16x16x32_bf16 v[60:63], a[112:115], v[140:143], v[60:63]
    s_add_u32 s53, s53, s36
    s_waitcnt vmcnt(17)
    v_mfma_f32_16x16x32_bf16 v[48:51], a[116:119], v[144:147], v[48:51]
    s_sub_u32 s54, s17, 3
    s_and_b32 s54, s54, 7
    v_mfma_f32_16x16x32_bf16 v[52:55], a[116:119], v[148:151], v[52:55]
    s_lshl_b32 s54, s54, 13
    s_add_u32 s54, s54, s36
    v_mfma_f32_16x16x32_bf16 v[56:59], a[116:119], v[152:155], v[56:59]
    s_sub_u32 s55, s17, 4
    s_and_b32 s55, s55, 7
    v_mfma_f32_16x16x32_bf16 v[60:63], a[116:119], v[156:159], v[60:63]
    s_lshl_b32 s55, s55, 13
    v_mfma_f32_16x16x32_bf16 v[48:51], a[120:123], v[160:163], v[48:51]
    s_add_u32 s55, s55, s36
    s_sub_u32 s56, s17, 5
    v_mfma_f32_16x16x32_bf16 v[52:55], a[120:123], v[164:167], v[52:55]
    s_and_b32 s56, s56, 7
    s_lshl_b32 s56, s56, 13
    v_mfma_f32_16x16x32_bf16 v[56:59], a[120:123], v[168:171], v[56:59]
    s_add_u32 s56, s56, s36
    s_sub_u32 s57, s17, 6
    v_mfma_f32_16x16x32_bf16 v[60:63], a[120:123], v[172:175], v[60:63]
    s_and_b32 s57, s57, 7
    s_waitcnt vmcnt(15)
    v_mfma_f32_16x16x32_bf16 v[48:51], a[124:127], v[176:179], v[48:51]
    s_lshl_b32 s57, s57, 13
    s_add_u32 s57, s57, s36
    v_mfma_f32_16x16x32_bf16 v[52:55], a[124:127], v[180:183], v[52:55]
    s_sub_u32 s58, s17, 7
    s_and_b32 s58, s58, 7
    v_mfma_f32_16x16x32_bf16 v[56:59], a[124:127], v[184:187], v[56:59]
    s_lshl_b32 s58, s58, 13
    s_add_u32 s58, s58, s36
    v_mfma_f32_16x16x32_bf16 v[60:63], a[124:127], v[188:191], v[60:63]
    s_waitcnt vmcnt(2)
    v_mfma_f32_16x16x32_bf16 v[48:51], a[128:131], v[192:195], v[48:51]
    v_cmp_eq_u32 vcc, 0, v19
    s_mov_b32 s48, 0x8000
    v_mfma_f32_16x16x32_bf16 v[52:55], a[128:131], v[196:199], v[52:55]
    s_and_b64 s[60:61], vcc, s[38:39]
    buffer_load_dwordx4 v[80:83], v2, s[12:15], s52 offen offset:0 sc1
    v_mfma_f32_16x16x32_bf16 v[56:59], a[128:131], v[200:203], v[56:59]
    buffer_load_dwordx4 v[84:87], v2, s[12:15], s52 offen offset:1024 sc1
    v_mfma_f32_16x16x32_bf16 v[60:63], a[128:131], v[204:207], v[60:63]
    buffer_load_dwordx4 v[88:91], v2, s[12:15], s53 offen offset:0 sc1
    s_waitcnt vmcnt(16)
    v_mfma_f32_16x16x32_bf16 v[48:51], a[132:135], v[208:211], v[48:51]
    buffer_load_dwordx4 v[92:95], v2, s[12:15], s53 offen offset:1024 sc1
    v_mfma_f32_16x16x32_bf16 v[52:55], a[132:135], v[212:215], v[52:55]
    buffer_load_dwordx4 v[96:99], v2, s[12:15], s54 offen offset:0 sc1
    v_mfma_f32_16x16x32_bf16 v[56:59], a[132:135], v[216:219], v[56:59]
    buffer_load_dwordx4 v[100:103], v2, s[12:15], s54 offen offset:1024 sc1
    v_mfma_f32_16x16x32_bf16 v[60:63], a[132:135], v[220:223], v[60:63]
    buffer_load_dwordx4 v[104:107], v2, s[12:15], s55 offen offset:0 sc1
    v_mfma_f32_16x16x32_bf16 v[48:51], a[136:139], v[224:227], v[48:51]
    buffer_load_dwordx4 v[108:111], v2, s[12:15], s55 offen offset:1024 sc1
    v_mfma_f32_16x16x32_bf16 v[52:55], a[136:139], v[228:231], v[52:55]
    s_add_u32 s37, s35, 0
    buffer_load_dword v112, v2, s[12:15], s37 offen sc1
    v_mfma_f32_16x16x32_bf16 v[56:59], a[136:139], v[232:235], v[56:59]
    s_add_u32 s37, s35, 8192
    buffer_load_dword v113, v2, s[12:15], s37 offen sc1
    v_mfma_f32_16x16x32_bf16 v[60:63], a[136:139], v[236:239], v[60:63]
    s_add_u32 s37, s35, 16384
    s_waitcnt vmcnt(21)
    v_mfma_f32_16x16x32_bf16 v[48:51], a[140:143], v[240:243], v[48:51]
    buffer_load_dword v114, v2, s[12:15], s37 offen sc1
    v_mfma_f32_16x16x32_bf16 v[52:55], a[140:143], v[244:247], v[52:55]
    s_add_u32 s37, s35, 24576
    buffer_load_dword v115, v2, s[12:15], s37 offen sc1
    v_mfma_f32_16x16x32_bf16 v[56:59], a[140:143], v[248:251], v[56:59]
    s_add_u32 s37, s35, 32768
    buffer_load_dword v116, v2, s[12:15], s37 offen sc1
    v_mfma_f32_16x16x32_bf16 v[60:63], a[140:143], v[252:255], v[60:63]
    s_add_u32 s37, s35, 40960
    v_mfma_f32_16x16x32_bf16 v[48:51], a[72:75], a[144:147], v[48:51]
    buffer_load_dword v117, v2, s[12:15], s37 offen sc1
    v_mfma_f32_16x16x32_bf16 v[52:55], a[72:75], a[148:151], v[52:55]
    s_add_u32 s37, s35, 49152
    buffer_load_dword v118, v2, s[12:15], s37 offen sc1
    v_mfma_f32_16x16x32_bf16 v[56:59], a[72:75], a[152:155], v[56:59]
    s_add_u32 s37, s35, 57344
    buffer_load_dword v119, v2, s[12:15], s37 offen sc1
    v_mfma_f32_16x16x32_bf16 v[60:63], a[72:75], a[156:159], v[60:63]
    s_mul_i32 s42, s18, 73728
    s_waitcnt vmcnt(25)
    v_mfma_f32_16x16x32_bf16 v[48:51], a[76:79], a[160:163], v[48:51]
    s_lshl_b32 s30, s30, 5
    s_add_u32 s30, s30, s42
    v_mfma_f32_16x16x32_bf16 v[52:55], a[76:79], a[164:167], v[52:55]
    s_mul_i32 s31, s32, 18432
    s_add_u32 s31, s31, s42
    v_mfma_f32_16x16x32_bf16 v[56:59], a[76:79], a[168:171], v[56:59]
    s_lshr_b32 s33, s25, 1
    s_add_u32 s31, s31, s33
    v_mfma_f32_16x16x32_bf16 v[60:63], a[76:79], a[172:175], v[60:63]
    s_lshl_b32 s33, s26, 2
    v_mfma_f32_16x16x32_bf16 v[48:51], a[80:83], a[176:179], v[48:51]
    s_add_u32 s31, s31, s33
    s_add_u32 s31, s31, 1024
    v_mfma_f32_16x16x32_bf16 v[52:55], a[80:83], a[180:183], v[52:55]
    s_cmp_eq_u32 s26, 0
    s_cselect_b64 vcc, 0, -1
    v_mfma_f32_16x16x32_bf16 v[56:59], a[80:83], a[184:187], v[56:59]
    s_waitcnt lgkmcnt(0)
    v_cndmask_b32 v78, v78, v79, vcc
    v_mfma_f32_16x16x32_bf16 v[60:63], a[80:83], a[188:191], v[60:63]
    s_cmp_eq_u64 s[60:61], 0
    s_waitcnt vmcnt(23)
    v_mfma_f32_16x16x32_bf16 v[48:51], a[84:87], a[192:195], v[48:51]
    v_mfma_f32_16x16x32_bf16 v[52:55], a[84:87], a[196:199], v[52:55]
    v_mfma_f32_16x16x32_bf16 v[56:59], a[84:87], a[200:203], v[56:59]
    v_mfma_f32_16x16x32_bf16 v[60:63], a[84:87], a[204:207], v[60:63]
    v_mfma_f32_16x16x32_bf16 v[48:51], a[88:91], a[208:211], v[48:51]
    v_mfma_f32_16x16x32_bf16 v[52:55], a[88:91], a[212:215], v[52:55]
    v_mfma_f32_16x16x32_bf16 v[56:59], a[88:91], a[216:219], v[56:59]
    v_mfma_f32_16x16x32_bf16 v[60:63], a[88:91], a[220:223], v[60:63]
    s_waitcnt vmcnt(19)
    v_mfma_f32_16x16x32_bf16 v[48:51], a[92:95], a[224:227], v[48:51]
    v_mfma_f32_16x16x32_bf16 v[52:55], a[92:95], a[228:231], v[52:55]
    v_mfma_f32_16x16x32_bf16 v[56:59], a[92:95], a[232:235], v[56:59]
    v_mfma_f32_16x16x32_bf16 v[60:63], a[92:95], a[236:239], v[60:63]
    v_mfma_f32_16x16x32_bf16 v[48:51], a[96:99], a[240:243], v[48:51]
    v_mfma_f32_16x16x32_bf16 v[52:55], a[96:99], a[244:247], v[52:55]
    v_mfma_f32_16x16x32_bf16 v[56:59], a[96:99], a[248:251], v[56:59]
    v_mfma_f32_16x16x32_bf16 v[60:63], a[96:99], a[252:255], v[60:63]
    s_cbranch_scc1 C_a_go
C_a_p:
    buffer_load_dword v19, v15, s[12:15], s34 offen sc1
    s_sub_u32 s48, s48, 1
    s_cbranch_scc1 C_a_to
    s_waitcnt vmcnt(0)
    v_cmp_eq_u32 vcc, 0, v19
    s_nop 1
    s_and_b64 s[60:61], vcc, s[38:39]
    s_cbranch_scc1 C_a_p
C_a_to:
    buffer_load_dwordx4 v[80:83], v2, s[12:15], s52 offen offset:0 sc1
    buffer_load_dwordx4 v[84:87], v2, s[12:15], s52 offen offset:1024 sc1
    buffer_load_dwordx4 v[88:91], v2, s[12:15], s53 offen offset:0 sc1
    buffer_load_dwordx4 v[92:95], v2, s[12:15], s53 offen offset:1024 sc1
    buffer_load_dwordx4 v[96:99], v2, s[12:15], s54 offen offset:0 sc1
    buffer_load_dwordx4 v[100:103], v2, s[12:15], s54 offen offset:1024 sc1
    buffer_load_dwordx4 v[104:107], v2, s[12:15], s55 offen offset:0 sc1
    buffer_load_dwordx4 v[108:111], v2, s[12:15], s55 offen offset:1024 sc1
    s_add_u32 s37, s35, 0
    buffer_load_dword v112, v2, s[12:15], s37 offen sc1
    s_add_u32 s37, s35, 8192
    buffer_load_dword v113, v2, s[12:15], s37 offen sc1
    s_add_u32 s37, s35, 16384
    buffer_load_dword v114, v2, s[12:15], s37 offen sc1
    s_add_u32 s37, s35, 24576
    buffer_load_dword v115, v2, s[12:15], s37 offen sc1
    s_add_u32 s37, s35, 32768
    buffer_load_dword v116, v2, s[12:15], s37 offen sc1
    s_add_u32 s37, s35, 40960
    buffer_load_dword v117, v2, s[12:15], s37 offen sc1
    s_add_u32 s37, s35, 49152
    buffer_load_dword v118, v2, s[12:15], s37 offen sc1
    s_add_u32 s37, s35, 57344
    buffer_load_dword v119, v2, s[12:15], s37 offen sc1
C_a_go:
    buffer_load_dwordx4 v[120:123], v2, s[12:15], s56 offen offset:0 sc1
    buffer_load_dwordx4 v[124:127], v2, s[12:15], s56 offen offset:1024 sc1
    buffer_load_dwordx4 v[128:131], v2, s[12:15], s57 offen offset:0 sc1
    buffer_load_dwordx4 v[132:135], v2, s[12:15], s57 offen offset:1024 sc1
    buffer_load_dwordx4 v[136:139], v2, s[12:15], s58 offen offset:0 sc1
    buffer_load_dwordx4 v[140:143], v2, s[12:15], s58 offen offset:1024 sc1
    s_waitcnt vmcnt(21)
    v_lshlrev_b32 v32, 16, v80
    v_and_b32 v33, 0xffff0000, v80
    v_lshlrev_b32 v34, 16, v81
    v_and_b32 v35, 0xffff0000, v81
    v_lshlrev_b32 v36, 16, v82
    v_and_b32 v37, 0xffff0000, v82
    v_lshlrev_b32 v38, 16, v83
    v_and_b32 v39, 0xffff0000, v83
    s_waitcnt vmcnt(20)
    v_lshlrev_b32 v40, 16, v84
    v_and_b32 v41, 0xffff0000, v84
    v_lshlrev_b32 v42, 16, v85
    v_and_b32 v43, 0xffff0000, v85
    v_lshlrev_b32 v44, 16, v86
    v_and_b32 v45, 0xffff0000, v86
    v_lshlrev_b32 v46, 16, v87
    v_and_b32 v47, 0xffff0000, v87
    s_waitcnt vmcnt(19)
    v_dot2c_f32_bf16 v32, s50, v88
    v_dot2c_f32_bf16 v33, s51, v88
    v_dot2c_f32_bf16 v34, s50, v89
    v_dot2c_f32_bf16 v35, s51, v89
    v_dot2c_f32_bf16 v36, s50, v90
    v_dot2c_f32_bf16 v37, s51, v90
    v_dot2c_f32_bf16 v38, s50, v91
    v_dot2c_f32_bf16 v39, s51, v91
    s_waitcnt vmcnt(18)
    v_dot2c_f32_bf16 v40, s50, v92
    v_dot2c_f32_bf16 v41, s51, v92
    v_dot2c_f32_bf16 v42, s50, v93
    v_dot2c_f32_bf16 v43, s51, v93
    v_dot2c_f32_bf16 v44, s50, v94
    v_dot2c_f32_bf16 v45, s51, v94
    v_dot2c_f32_bf16 v46, s50, v95
    v_dot2c_f32_bf16 v47, s51, v95
    s_waitcnt vmcnt(17)
    v_dot2c_f32_bf16 v32, s50, v96
    v_dot2c_f32_bf16 v33, s51, v96
    v_dot2c_f32_bf16 v34, s50, v97
    v_dot2c_f32_bf16 v35, s51, v97
    v_dot2c_f32_bf16 v36, s50, v98
    v_dot2c_f32_bf16 v37, s51, v98
    v_dot2c_f32_bf16 v38, s50, v99
    v_dot2c_f32_bf16 v39, s51, v99
    s_waitcnt vmcnt(16)
    v_dot2c_f32_bf16 v40, s50, v100
    v_dot2c_f32_bf16 v41, s51, v100
    v_dot2c_f32_bf16 v42, s50, v101
    v_dot2c_f32_bf16 v43, s51, v101
    v_dot2c_f32_bf16 v44, s50, v102
    v_dot2c_f32_bf16 v45, s51, v102
    v_dot2c_f32_bf16 v46, s50, v103
    v_dot2c_f32_bf16 v47, s51, v103
    s_waitcnt vmcnt(15)
    v_dot2c_f32_bf16 v32, s50, v104
    v_dot2c_f32_bf16 v33, s51, v104
    v_dot2c_f32_bf16 v34, s50, v105
    v_dot2c_f32_bf16 v35, s51, v105
    v_dot2c_f32_bf16 v36, s50, v106
    v_dot2c_f32_bf16 v37, s51, v106
    v_dot2c_f32_bf16 v38, s50, v107
    v_dot2c_f32_bf16 v39, s51, v107
    s_waitcnt vmcnt(14)
    v_dot2c_f32_bf16 v40, s50, v108
    v_dot2c_f32_bf16 v41, s51, v108
    v_dot2c_f32_bf16 v42, s50, v109
    v_dot2c_f32_bf16 v43, s51, v109
    v_dot2c_f32_bf16 v44, s50, v110
    v_dot2c_f32_bf16 v45, s51, v110
    v_dot2c_f32_bf16 v46, s50, v111
    v_dot2c_f32_bf16 v47, s51, v111
    s_waitcnt vmcnt(6)
    v_dot2c_f32_bf16 v20, s50, v112
    v_dot2c_f32_bf16 v21, s51, v112
    v_dot2c_f32_bf16 v20, s50, v113
    v_dot2c_f32_bf16 v21, s51, v113
    v_dot2c_f32_bf16 v20, s50, v114
    v_dot2c_f32_bf16 v21, s51, v114
    v_dot2c_f32_bf16 v20, s50, v115
    v_dot2c_f32_bf16 v21, s51, v115
    v_dot2c_f32_bf16 v20, s50, v116
    v_dot2c_f32_bf16 v21, s51, v116
    v_dot2c_f32_bf16 v20, s50, v117
    v_dot2c_f32_bf16 v21, s51, v117
    v_dot2c_f32_bf16 v20, s50, v118
    v_dot2c_f32_bf16 v21, s51, v118
    v_dot2c_f32_bf16 v20, s50, v119
    v_dot2c_f32_bf16 v21, s51, v119
    v_pk_add_f32 v[32:33], v[32:33], v[48:49]
    v_pk_add_f32 v[34:35], v[34:35], v[50:51]
    v_pk_add_f32 v[36:37], v[36:37], v[52:53]
    v_pk_add_f32 v[38:39], v[38:39], v[54:55]
    v_pk_add_f32 v[40:41], v[40:41], v[56:57]
    v_pk_add_f32 v[42:43], v[42:43], v[58:59]
    v_pk_add_f32 v[44:45], v[44:45], v[60:61]
    v_pk_add_f32 v[46:47], v[46:47], v[62:63]
    v_mul_f32 v20, v20, v14
    v_mul_f32 v21, v21, v14
    v_lshlrev_b32 v24, 16, v78
    v_and_b32 v25, 0xffff0000, v78
    v_fmac_f32 v24, v68, v20
    v_fmac_f32 v25, v69, v21
    v_cvt_pk_bf16_f32 v24, v24, v25
    s_mov_b32 s48, 0x8000
    buffer_store_dword v24, v16, s[8:11], s31 offen
    s_waitcnt vmcnt(1)
C_b_p:
    v_max_u32 v19, v120, v121
    v_max_u32 v18, v122, v123
    v_max3_u32 v19, v19, v124, v125
    v_max3_u32 v18, v18, v126, v127
    v_max3_u32 v19, v19, v128, v129
    v_max3_u32 v18, v18, v130, v131
    v_max3_u32 v19, v19, v132, v133
    v_max3_u32 v18, v18, v134, v135
    v_max3_u32 v19, v19, v136, v137
    v_max3_u32 v18, v18, v138, v139
    v_max3_u32 v19, v19, v140, v141
    v_max3_u32 v18, v18, v142, v143
    v_max_u32 v19, v18, v19
    v_cmp_eq_u32 vcc, -1, v19
    s_sub_u32 s48, s48, 1
    s_cbranch_scc1 C_b_go
    s_cbranch_vccz C_b_go
    buffer_load_dwordx4 v[120:123], v2, s[12:15], s56 offen offset:0 sc1
    buffer_load_dwordx4 v[124:127], v2, s[12:15], s56 offen offset:1024 sc1
    buffer_load_dwordx4 v[128:131], v2, s[12:15], s57 offen offset:0 sc1
    buffer_load_dwordx4 v[132:135], v2, s[12:15], s57 offen offset:1024 sc1
    buffer_load_dwordx4 v[136:139], v2, s[12:15], s58 offen offset:0 sc1
    buffer_load_dwordx4 v[140:143], v2, s[12:15], s58 offen offset:1024 sc1
    s_waitcnt vmcnt(0)
    s_branch C_b_p
C_b_go:
    v_dot2c_f32_bf16 v32, s50, v120
    v_dot2c_f32_bf16 v33, s51, v120
    v_dot2c_f32_bf16 v34, s50, v121
    v_dot2c_f32_bf16 v35, s51, v121
    v_dot2c_f32_bf16 v36, s50, v122
    v_dot2c_f32_bf16 v37, s51, v122
    v_dot2c_f32_bf16 v38, s50, v123
    v_dot2c_f32_bf16 v39, s51, v123
    v_dot2c_f32_bf16 v40, s50, v124
    v_dot2c_f32_bf16 v41, s51, v124
    v_dot2c_f32_bf16 v42, s50, v125
    v_dot2c_f32_bf16 v43, s51, v125
    v_dot2c_f32_bf16 v44, s50, v126
    v_dot2c_f32_bf16 v45, s51, v126
    v_dot2c_f32_bf16 v46, s50, v127
    v_dot2c_f32_bf16 v47, s51, v127
    v_dot2c_f32_bf16 v32, s50, v128
    v_dot2c_f32_bf16 v33, s51, v128
    v_dot2c_f32_bf16 v34, s50, v129
    v_dot2c_f32_bf16 v35, s51, v129
    v_dot2c_f32_bf16 v36, s50, v130
    v_dot2c_f32_bf16 v37, s51, v130
    v_dot2c_f32_bf16 v38, s50, v131
    v_dot2c_f32_bf16 v39, s51, v131
    v_dot2c_f32_bf16 v40, s50, v132
    v_dot2c_f32_bf16 v41, s51, v132
    v_dot2c_f32_bf16 v42, s50, v133
    v_dot2c_f32_bf16 v43, s51, v133
    v_dot2c_f32_bf16 v44, s50, v134
    v_dot2c_f32_bf16 v45, s51, v134
    v_dot2c_f32_bf16 v46, s50, v135
    v_dot2c_f32_bf16 v47, s51, v135
    v_dot2c_f32_bf16 v32, s50, v136
    v_dot2c_f32_bf16 v33, s51, v136
    v_dot2c_f32_bf16 v34, s50, v137
    v_dot2c_f32_bf16 v35, s51, v137
    v_dot2c_f32_bf16 v36, s50, v138
    v_dot2c_f32_bf16 v37, s51, v138
    v_dot2c_f32_bf16 v38, s50, v139
    v_dot2c_f32_bf16 v39, s51, v139
    v_dot2c_f32_bf16 v40, s50, v140
    v_dot2c_f32_bf16 v41, s51, v140
    v_dot2c_f32_bf16 v42, s50, v141
    v_dot2c_f32_bf16 v43, s51, v141
    v_dot2c_f32_bf16 v44, s50, v142
    v_dot2c_f32_bf16 v45, s51, v142
    v_dot2c_f32_bf16 v46, s50, v143
    v_dot2c_f32_bf16 v47, s51, v143
    v_lshlrev_b32 v80, 16, v70
    v_and_b32 v81, 0xffff0000, v70
    v_lshlrev_b32 v82, 16, v71
    v_and_b32 v83, 0xffff0000, v71
    v_mul_f32 v32, v32, v10
    v_mul_f32 v33, v33, v10
    v_mul_f32 v34, v34, v10
    v_mul_f32 v35, v35, v10
    v_fmac_f32 v80, v64, v32
    v_fmac_f32 v81, v65, v33
    v_fmac_f32 v82, v66, v34
    v_fmac_f32 v83, v67, v35
    v_cvt_pk_bf16_f32 v70, v80, v81
    v_cvt_pk_bf16_f32 v71, v82, v83
    buffer_store_dwordx2 v[70:71], v16, s[8:11], s30 offen
    s_add_u32 s30, s30, 18432
    v_lshlrev_b32 v84, 16, v72
    v_and_b32 v85, 0xffff0000, v72
    v_lshlrev_b32 v86, 16, v73
    v_and_b32 v87, 0xffff0000, v73
    v_mul_f32 v36, v36, v11
    v_mul_f32 v37, v37, v11
    v_mul_f32 v38, v38, v11
    v_mul_f32 v39, v39, v11
    v_fmac_f32 v84, v64, v36
    v_fmac_f32 v85, v65, v37
    v_fmac_f32 v86, v66, v38
    v_fmac_f32 v87, v67, v39
    v_cvt_pk_bf16_f32 v72, v84, v85
    v_cvt_pk_bf16_f32 v73, v86, v87
    buffer_store_dwordx2 v[72:73], v16, s[8:11], s30 offen
    s_add_u32 s30, s30, 18432
    v_lshlrev_b32 v88, 16, v74
    v_and_b32 v89, 0xffff0000, v74
    v_lshlrev_b32 v90, 16, v75
    v_and_b32 v91, 0xffff0000, v75
    v_mul_f32 v40, v40, v12
    v_mul_f32 v41, v41, v12
    v_mul_f32 v42, v42, v12
    v_mul_f32 v43, v43, v12
    v_fmac_f32 v88, v64, v40
    v_fmac_f32 v89, v65, v41
    v_fmac_f32 v90, v66, v42
    v_fmac_f32 v91, v67, v43
    v_cvt_pk_bf16_f32 v74, v88, v89
    v_cvt_pk_bf16_f32 v75, v90, v91
    buffer_store_dwordx2 v[74:75], v16, s[8:11], s30 offen
    s_add_u32 s30, s30, 18432
    v_lshlrev_b32 v92, 16, v76
    v_and_b32 v93, 0xffff0000, v76
    v_lshlrev_b32 v94, 16, v77
    v_and_b32 v95, 0xffff0000, v77
    v_mul_f32 v44, v44, v13
    v_mul_f32 v45, v45, v13
    v_mul_f32 v46, v46, v13
    v_mul_f32 v47, v47, v13
    v_fmac_f32 v92, v64, v44
    v_fmac_f32 v93, v65, v45
    v_fmac_f32 v94, v66, v46
    v_fmac_f32 v95, v67, v47
    v_cvt_pk_bf16_f32 v76, v92, v93
    v_cvt_pk_bf16_f32 v77, v94, v95
    buffer_store_dwordx2 v[76:77], v16, s[8:11], s30 offen
    s_add_u32 s30, s30, 18432
C_exit:
    s_endpgm

.section .rodata,"a"
.p2align 6
.amdhsa_kernel ffn_kernel
  .amdhsa_next_free_vgpr 512
  .amdhsa_next_free_sgpr 64
  .amdhsa_accum_offset 256
  .amdhsa_group_segment_fixed_size 0
  .amdhsa_kernarg_size 120
  .amdhsa_user_sgpr_count 2
  .amdhsa_user_sgpr_kernarg_segment_ptr 1
  .amdhsa_system_sgpr_workgroup_id_x 1
.end_amdhsa_kernel
```
